```python
import torch

def _softmax(x, axis=-1):
    return torch.softmax(x, dim=axis)
def _gelu(x):
    return torch.nn.functional.gelu(x, approximate="tanh")
def _silu(x):
    return torch.nn.functional.silu(x)
def _sigmoid(x):
    return torch.sigmoid(x)
def _layernorm(x, axis=-1, eps=1e-5):
    m = x.mean(dim=axis, keepdim=True)
    v = x.var(dim=axis, keepdim=True, unbiased=False)
    return (x - m) / torch.sqrt(v + eps)
def _scatter_add(tgt, idx, src, axis=0):
    return tgt.clone().index_add_(axis, idx, src)
def _segment_sum(src, seg, n):
    out = torch.zeros((n,) + src.shape[1:], dtype=src.dtype)
    return out.index_add_(0, seg, src)
def _pad(x, pw):
    flat = tuple(v for pair in reversed(pw) for v in pair)
    return torch.nn.functional.pad(x, flat)

kernel_name = 'concat_heads__spectral_gfnet__ssm_conv_h3__prompt'

def setup_inputs():

    _w = (lambda a: (lambda t: t.to(torch.bfloat16) if t.is_floating_point() else t)(torch.as_tensor(a)))
    def _A_setup():
        B, S, D = 1, 2048, 1024
        Df = D // 2 + 1
        return {
            "x": _w((lambda *s: torch.randn(*s, dtype=torch.bfloat16) * 0.05)(B, S, D)),
            "w_r": _w((lambda *s: torch.randn(*s, dtype=torch.bfloat16) * 0.05)(S, Df) * 0.02),
            "w_i": _w((lambda *s: torch.randn(*s, dtype=torch.bfloat16) * 0.05)(S, Df) * 0.02),
        }
    _A_in = _A_setup()

    def _B_setup():
        B, S, D = 1, 2048, 1024
        ks = 4
        return {
            "q": _w((lambda *s: torch.randn(*s, dtype=torch.bfloat16) * 0.05)(B, S, D)),
            "k": _w((lambda *s: torch.randn(*s, dtype=torch.bfloat16) * 0.1)(B, S, D)),
            "v": _w((lambda *s: torch.randn(*s, dtype=torch.bfloat16) * 0.1)(B, S, D)),
            "shift_k": _w((lambda *s: torch.randn(*s, dtype=torch.bfloat16) * 0.1)(D, ks) * 0.5),
            "ssm_k": _w((lambda *s: torch.randn(*s, dtype=torch.bfloat16) * 0.1)(D, S) * (1.0 / S ** 0.5)),
            "ssm_D": _w((lambda *s: torch.randn(*s, dtype=torch.bfloat16) * 0.1)(D)),
        }
    _B_in = _B_setup()

    return {
        "A_x": _A_in["x"],
        "A_w_r": _A_in["w_r"],
        "A_w_i": _A_in["w_i"],
        "B_q": _B_in["q"],
        "B_k": _B_in["k"],
        "B_v": _B_in["v"],
        "B_shift_k": _B_in["shift_k"],
        "B_ssm_k": _B_in["ssm_k"],
        "B_ssm_D": _B_in["ssm_D"],
    }

def reference(A_x, A_w_r, A_w_i, B_q, B_k, B_v, B_shift_k, B_ssm_k, B_ssm_D):
    def _A_ref(x, w_r, w_i):
        B, S, D = x.shape
        X = (lambda x, axes=(-2,-1): torch.fft.rfft2(x.float(), dim=axes))(x, axes=(-2, -1))
        W = w_r + 1j * w_i
        X = X * W
        y = (lambda x, s, axes=(-2,-1): torch.fft.irfft2(x, s=s, dim=axes).to(torch.bfloat16))(X, (S, D), axes=(-2, -1))
        return y

    def _B_ref(q, k, v, shift_k, ssm_k, ssm_D):
        B, S, D = q.shape
        ks = shift_k.shape[-1]
        k_pad = _pad(k, ((0, 0), (ks - 1, 0), (0, 0)))
        k_shift = torch.zeros_like(k)
        for t in range(ks):
            k_shift = k_shift + k_pad[:, t:t + S, :] * shift_k[:, ks - 1 - t][None, None, :]
        kv = k_shift * v
        L = 2 * S
        kv_pad = _pad(kv, ((0, 0), (0, S), (0, 0)))
        kf_pad = _pad(ssm_k, ((0, 0), (0, S)))
        kv_f = (lambda x, axes=(-2,-1): torch.fft.rfft2(x.float(), dim=axes))(kv_pad[:, None, :, :], axes=(1, 2))
        kf_f = (lambda x, axes=(-2,-1): torch.fft.rfft2(x.float(), dim=axes))(kf_pad[:, None, :], axes=(1, 2))
        kf_f = (lambda x, *d: x.permute(*d))(kf_f, 1, 2, 0)
        y_f = kv_f * kf_f[None, :, :, :]
        y = (lambda x, s, axes=(-2,-1): torch.fft.irfft2(x, s=s, dim=axes).to(torch.bfloat16))(y_f, (1, L), axes=(1, 2))[:, 0, :S, :]
        y = y + kv * ssm_D[None, None, :]
        return q * y

    a = _A_ref(A_x, A_w_r, A_w_i)
    b = _B_ref(B_q, B_k, B_v, B_shift_k, B_ssm_k, B_ssm_D)
    return torch.concatenate([a, b], axis=-1)
```

```asm
; @launch grid=(512,1,1) block=(256,1,1) lds=53248
.amdgcn_target "amdgcn-amd-amdhsa--gfx950"
.text
.globl concat_heads__spectral_gfnet__ssm_conv_h3__prompt_kernel
.p2align 8
.type concat_heads__spectral_gfnet__ssm_conv_h3__prompt_kernel,@function
concat_heads__spectral_gfnet__ssm_conv_h3__prompt_kernel:
    s_cmp_ge_u32 s2, 512
    s_cbranch_scc1 L_exit
    s_load_dwordx16 s[4:19], s[0:1], 0
    s_load_dwordx8 s[20:27], s[0:1], 64
    v_lshrrev_b32 v1, 6, v0
    s_nop 0
    v_readfirstlane_b32 s3, v1
    v_and_b32 v1, 63, v0
    s_waitcnt lgkmcnt(0)
    s_add_u32 s28, s26, 20971520
    s_addc_u32 s29, s27, 0
    s_mov_b32 s30, 1048576
    s_mov_b32 s31, 0x00020000
    s_mov_b32 s92, 20971520
    s_load_dword s101, s[26:27], s92
    s_mov_b32 s98, 4096
    s_mov_b32 s99, 8192
    s_mov_b32 s100, 12288
    s_and_b32 s91, s2, 255
    s_bitcmp0_b32 s2, 3
    s_cselect_b32 s88, 1, 0
    s_lshr_b32 s48, s91, 4
    s_lshl_b32 s48, s48, 3
    s_and_b32 s49, s91, 7
    s_add_u32 s48, s48, s49
    s_and_b32 s89, s48, 15
    s_lshr_b32 s48, s48, 4
    s_lshl_b32 s48, s48, 1
    s_lshr_b32 s49, s2, 8
    s_add_u32 s90, s48, s49
    s_cmp_ge_u32 s2, 256
    s_cbranch_scc1 L_A
    s_setprio 2
    s_and_b32 s40, s2, 15
    s_lshr_b32 s41, s2, 4
    s_mov_b32 s89, s40
    s_mov_b32 s90, s41
    s_lshl_b32 s48, s90, 7
    s_lshl_b32 s51, s3, 5
    s_add_u32 s48, s48, s51
    s_lshl_b32 s49, s89, 6
    s_mov_b32 s52, s12
    s_mov_b32 s53, s13
    s_mov_b32 s54, 4194304
    s_mov_b32 s55, 0x00020000
    v_and_b32 v2, 15, v1
    v_lshrrev_b32 v3, 4, v1
    v_lshl_add_u32 v4, v3, 3, s48
    v_lshl_add_u32 v5, v2, 2, s49
    v_lshlrev_b32 v6, 11, v4
    v_lshl_add_u32 v6, v5, 1, v6
    v_subrev_u32 v7, 6144, v6
    s_mov_b32 s68, 4096
    s_mov_b32 s69, 8192
    s_mov_b32 s70, 12288
    buffer_load_dwordx2 v[16:17], v7, s[52:55], 0 offen nt
    buffer_load_dwordx2 v[18:19], v7, s[52:55], 0 offen offset:2048 nt
    buffer_load_dwordx2 v[20:21], v7, s[52:55], s68 offen nt
    buffer_load_dwordx2 v[22:23], v6, s[52:55], 0 offen nt
    buffer_load_dwordx2 v[24:25], v6, s[52:55], 0 offen offset:2048 nt
    buffer_load_dwordx2 v[26:27], v6, s[52:55], s68 offen nt
    buffer_load_dwordx2 v[28:29], v6, s[52:55], s68 offen offset:2048 nt
    buffer_load_dwordx2 v[30:31], v6, s[52:55], s69 offen nt
    buffer_load_dwordx2 v[32:33], v6, s[52:55], s69 offen offset:2048 nt
    buffer_load_dwordx2 v[34:35], v6, s[52:55], s70 offen nt
    buffer_load_dwordx2 v[36:37], v6, s[52:55], s70 offen offset:2048 nt
    s_mov_b32 s60, s16
    s_mov_b32 s61, s17
    s_mov_b32 s62, 8192
    s_mov_b32 s63, 0x00020000
    s_mov_b32 s56, s14
    s_mov_b32 s57, s15
    s_mov_b32 s58, 4194304
    s_mov_b32 s59, 0x00020000
    v_lshlrev_b32 v9, 3, v5
    buffer_load_dwordx4 v[54:57], v9, s[60:63], 0 offen
    buffer_load_dwordx4 v[58:61], v9, s[60:63], 0 offen offset:16
    buffer_load_dwordx2 v[38:39], v6, s[56:59], 0 offen nt
    buffer_load_dwordx2 v[40:41], v6, s[56:59], 0 offen offset:2048 nt
    buffer_load_dwordx2 v[42:43], v6, s[56:59], s68 offen nt
    buffer_load_dwordx2 v[44:45], v6, s[56:59], s68 offen offset:2048 nt
    buffer_load_dwordx2 v[46:47], v6, s[56:59], s69 offen nt
    buffer_load_dwordx2 v[48:49], v6, s[56:59], s69 offen offset:2048 nt
    buffer_load_dwordx2 v[50:51], v6, s[56:59], s70 offen nt
    buffer_load_dwordx2 v[52:53], v6, s[56:59], s70 offen offset:2048 nt
    s_mov_b32 s64, s22
    s_mov_b32 s65, s23
    s_mov_b32 s66, 8388608
    s_mov_b32 s67, 0x00020000
    s_mov_b32 s71, 16384
    s_mov_b32 s76, 20480
    s_mov_b32 s77, 24576
    s_mov_b32 s78, 28672
    s_mov_b32 s50, 0xffff0000
    s_lshl_b32 s51, s90, 7
    s_lshl_b32 s92, s3, 5
    s_add_u32 s51, s51, s92
    s_lshl_b32 s51, s51, 12
    s_lshl_b32 s92, s89, 7
    s_add_u32 s51, s51, s92
    s_add_u32 s51, s51, 2048
    v_lshrrev_b32 v8, 1, v2
    v_lshlrev_b32 v8, 12, v8
    v_lshl_add_u32 v8, v3, 4, v8
    v_and_b32 v2, 1, v2
    v_lshl_add_u32 v8, v2, 6, v8
    v_add_u32 v8, s51, v8
    s_mov_b32 s32, 32768
    s_mov_b32 s33, 65536
    s_mov_b32 s34, 98304
    s_waitcnt lgkmcnt(0)
    s_add_u32 s101, s101, 1
    s_getreg_b32 s92, hwreg(HW_REG_XCC_ID)
    s_and_b32 s92, s92, 15
    s_lshl_b32 s0, s101, 4
    s_or_b32 s0, s0, s92
    s_cmp_lg_u32 s3, 0
    s_cbranch_scc1 L_pub_3
    s_and_b32 s92, s2, 15
    s_lshl_b32 s92, s92, 4
    s_lshr_b32 s93, s2, 4
    s_add_u32 s92, s92, s93
    s_lshl_b32 s92, s92, 6
    s_add_u32 s92, s92, 69632
    v_mov_b32 v10, s92
    v_mov_b32 v11, s0
    s_mov_b64 exec, 1
    buffer_store_dword v11, v10, s[28:31], 0 offen sc1
    s_mov_b64 exec, -1
L_pub_3:
    s_mov_b32 s80, s18
    s_mov_b32 s81, s19
    s_mov_b32 s82, 4194304
    s_mov_b32 s83, 0x00020000
    s_mov_b32 s84, s22
    s_mov_b32 s85, s23
    s_mov_b32 s86, 8388608
    s_mov_b32 s87, 0x00020000
    s_and_b32 s40, s2, 15
    s_lshr_b32 s41, s2, 4
    s_lshl_b32 s42, s40, 4
    s_add_u32 s42, s42, s41
    s_lshl_b32 s42, s42, 2
    s_add_u32 s42, s42, s3
    s_lshl_b32 s43, s42, 12
    s_mul_i32 s44, s3, 12896
    s_mov_b32 s72, 0xffff0000
    s_and_b32 s73, s42, 3
    s_lshl_b32 s73, s73, 15
    s_bfe_u32 s74, s42, 0x30003
    s_lshl_b32 s74, s74, 12
    s_add_u32 s73, s73, s74
    s_bfe_u32 s74, s42, 0x10002
    s_lshl_b32 s74, s74, 6
    s_add_u32 s73, s73, s74
    s_lshl_b32 s74, s40, 7
    s_add_u32 s73, s73, s74
    s_add_u32 s36, s73, 2048
    s_add_u32 s37, s36, 2097152
    s_add_u32 s38, s36, 4194304
    s_add_u32 s39, s36, 6291456
    s_lshl_b32 s73, s40, 10
    s_add_u32 s46, s73, 36864
    s_lshl_b32 s74, s41, 6
    s_add_u32 s73, s73, s74
    s_add_u32 s47, s73, 53248
    s_and_b32 s73, s42, 0xfffffffe
    s_lshl_b32 s73, s73, 1
    s_load_dword s45, s[20:21], s73
    v_lshlrev_b32 v12, 2, v1
    v_add_u32 v13, 4128, v12
    v_cmp_le_u32 vcc, 8, v1
    s_nop 1
    v_cndmask_b32 v15, v12, v13, vcc
    v_add_u32 v13, 8288, v12
    v_cmp_le_u32 vcc, 16, v1
    s_nop 1
    v_cndmask_b32 v15, v15, v13, vcc
    v_add_u32 v231, s44, v15
    v_lshlrev_b32 v12, 3, v1
    v_add_u32 v12, s44, v12
    v_mov_b32 v228, 0
    v_mov_b32 v229, 0
    ds_write_b64 v12, v[228:229] offset:8288
    v_and_b32 v244, 15, v1
    v_lshrrev_b32 v245, 4, v1
    v_and_b32 v236, 1, v244
    v_xor_b32 v236, 1, v236
    v_mul_u32_u24 v236, 4160, v236
    v_add_u32 v237, 1, v244
    v_lshrrev_b32 v237, 1, v237
    v_lshl_add_u32 v236, v237, 2, v236
    v_lshlrev_b32 v237, 4, v245
    v_sub_u32 v236, v236, v237
    s_add_u32 s73, s44, 16
    v_add_u32 v236, s73, v236
    v_add_u32 v237, 1024, v236
    v_add_u32 v238, 2048, v236
    v_add_u32 v239, 3072, v236
    v_lshlrev_b32 v240, 5, v244
    v_lshl_add_u32 v240, v245, 4, v240
    s_add_u32 s73, s44, 8320
    v_add_u32 v240, s73, v240
    v_lshrrev_b32 v227, 1, v245
    v_lshlrev_b32 v243, 4, v227
    v_lshl_add_u32 v243, v244, 5, v243
    v_and_b32 v227, 1, v245
    v_xor_b32 v227, 1, v227
    v_lshl_add_u32 v243, v227, 3, v243
    s_add_u32 s73, s44, 8800
    v_add_u32 v232, s73, v243
    v_lshrrev_b32 v227, 3, v244
    v_lshlrev_b32 v241, 19, v227
    v_bfe_u32 v227, v244, 1, 2
    v_lshl_add_u32 v241, v227, 17, v241
    v_and_b32 v227, 1, v245
    v_lshl_add_u32 v241, v227, 20, v241
    v_and_b32 v227, 1, v244
    v_lshl_add_u32 v241, v227, 5, v241
    v_lshrrev_b32 v227, 1, v245
    v_lshl_add_u32 v241, v227, 4, v241
    v_lshlrev_b32 v242, 19, v245
    v_bfe_u32 v227, v1, 2, 2
    v_lshl_add_u32 v242, v227, 17, v242
    v_and_b32 v227, 3, v1
    v_lshl_add_u32 v242, v227, 4, v242
    v_lshlrev_b32 v227, 4, v1
    s_add_u32 s73, s44, 8800
    v_add_u32 v243, s73, v227
    s_cmp_eq_u32 s3, 0
    s_cbranch_scc1 L_wv_4
    s_waitcnt vmcnt(20)
L_wv_4:
    s_waitcnt vmcnt(21)
    v_lshlrev_b32 v64, 16, v16
    v_and_b32 v65, s50, v16
    v_lshlrev_b32 v66, 16, v17
    v_and_b32 v67, s50, v17
    s_cbranch_scc1 L_wv_5
    s_waitcnt vmcnt(19)
L_wv_5:
    s_waitcnt vmcnt(20)
    v_lshlrev_b32 v68, 16, v18
    v_and_b32 v69, s50, v18
    v_lshlrev_b32 v70, 16, v19
    v_and_b32 v71, s50, v19
    s_cbranch_scc1 L_wv_6
    s_waitcnt vmcnt(18)
L_wv_6:
    s_waitcnt vmcnt(19)
    v_lshlrev_b32 v72, 16, v20
    v_and_b32 v73, s50, v20
    v_lshlrev_b32 v74, 16, v21
    v_and_b32 v75, s50, v21
    s_cbranch_scc1 L_wv_7
    s_waitcnt vmcnt(17)
L_wv_7:
    s_waitcnt vmcnt(18)
    v_lshlrev_b32 v76, 16, v22
    v_and_b32 v77, s50, v22
    v_lshlrev_b32 v78, 16, v23
    v_and_b32 v79, s50, v23
    s_cbranch_scc1 L_wv_8
    s_waitcnt vmcnt(16)
L_wv_8:
    s_waitcnt vmcnt(17)
    v_lshlrev_b32 v80, 16, v24
    v_and_b32 v81, s50, v24
    v_lshlrev_b32 v82, 16, v25
    v_and_b32 v83, s50, v25
    s_cbranch_scc1 L_wv_9
    s_waitcnt vmcnt(15)
L_wv_9:
    s_waitcnt vmcnt(16)
    v_lshlrev_b32 v84, 16, v26
    v_and_b32 v85, s50, v26
    v_lshlrev_b32 v86, 16, v27
    v_and_b32 v87, s50, v27
    s_cbranch_scc1 L_wv_10
    s_waitcnt vmcnt(14)
L_wv_10:
    s_waitcnt vmcnt(15)
    v_lshlrev_b32 v88, 16, v28
    v_and_b32 v89, s50, v28
    v_lshlrev_b32 v90, 16, v29
    v_and_b32 v91, s50, v29
    s_cbranch_scc1 L_wv_11
    s_waitcnt vmcnt(13)
L_wv_11:
    s_waitcnt vmcnt(14)
    v_lshlrev_b32 v92, 16, v30
    v_and_b32 v93, s50, v30
    v_lshlrev_b32 v94, 16, v31
    v_and_b32 v95, s50, v31
    s_cbranch_scc1 L_wv_12
    s_waitcnt vmcnt(12)
L_wv_12:
    s_waitcnt vmcnt(13)
    v_lshlrev_b32 v96, 16, v32
    v_and_b32 v97, s50, v32
    v_lshlrev_b32 v98, 16, v33
    v_and_b32 v99, s50, v33
    s_cbranch_scc1 L_wv_13
    s_waitcnt vmcnt(11)
L_wv_13:
    s_waitcnt vmcnt(12)
    v_lshlrev_b32 v100, 16, v34
    v_and_b32 v101, s50, v34
    v_lshlrev_b32 v102, 16, v35
    v_and_b32 v103, s50, v35
    s_cbranch_scc1 L_wv_14
    s_waitcnt vmcnt(10)
L_wv_14:
    s_waitcnt vmcnt(11)
    v_lshlrev_b32 v104, 16, v36
    v_and_b32 v105, s50, v36
    v_lshlrev_b32 v106, 16, v37
    v_and_b32 v107, s50, v37
    s_cbranch_scc1 L_wv_15
    s_waitcnt vmcnt(8)
L_wv_15:
    s_waitcnt vmcnt(9)
    v_lshlrev_b32 v108, 16, v54
    v_and_b32 v112, s50, v54
    v_lshlrev_b32 v116, 16, v55
    v_and_b32 v120, s50, v55
    v_lshlrev_b32 v109, 16, v56
    v_and_b32 v113, s50, v56
    v_lshlrev_b32 v117, 16, v57
    v_and_b32 v121, s50, v57
    v_lshlrev_b32 v110, 16, v58
    v_and_b32 v114, s50, v58
    v_lshlrev_b32 v118, 16, v59
    v_and_b32 v122, s50, v59
    v_lshlrev_b32 v111, 16, v60
    v_and_b32 v115, s50, v60
    v_lshlrev_b32 v119, 16, v61
    v_and_b32 v123, s50, v61
    v_min_u32 v10, 15, v1
    s_and_b32 s93, s2, 15
    s_lshl_b32 s93, s93, 4
    v_add_u32 v10, s93, v10
    v_lshlrev_b32 v10, 6, v10
    v_add_u32 v10, 69632, v10
    s_cmp_lg_u32 s3, 0
    s_cbranch_scc1 L_li_16
    buffer_load_dword v11, v10, s[28:31], 0 offen sc1
L_li_16:
    s_cmp_eq_u32 s3, 0
    s_cbranch_scc1 L_wv_17
    s_waitcnt vmcnt(7)
L_wv_17:
    s_waitcnt vmcnt(9)
    v_lshlrev_b32 v156, 16, v38
    v_and_b32 v157, s50, v38
    v_lshlrev_b32 v158, 16, v39
    v_and_b32 v159, s50, v39
    v_pk_mul_f32 v[124:125], v[76:77], v[108:109]
    v_pk_fma_f32 v[124:125], v[72:73], v[112:113], v[124:125]
    v_pk_fma_f32 v[124:125], v[68:69], v[116:117], v[124:125]
    v_pk_fma_f32 v[124:125], v[64:65], v[120:121], v[124:125]
    v_pk_mul_f32 v[124:125], v[124:125], v[156:157]
    v_pk_mul_f32 v[126:127], v[78:79], v[110:111]
    v_pk_fma_f32 v[126:127], v[74:75], v[114:115], v[126:127]
    v_pk_fma_f32 v[126:127], v[70:71], v[118:119], v[126:127]
    v_pk_fma_f32 v[126:127], v[66:67], v[122:123], v[126:127]
    v_pk_mul_f32 v[126:127], v[126:127], v[158:159]
    s_cbranch_scc1 L_wv_18
    s_waitcnt vmcnt(6)
L_wv_18:
    s_waitcnt vmcnt(8)
    v_lshlrev_b32 v156, 16, v40
    v_and_b32 v157, s50, v40
    v_lshlrev_b32 v158, 16, v41
    v_and_b32 v159, s50, v41
    v_pk_mul_f32 v[128:129], v[80:81], v[108:109]
    v_pk_fma_f32 v[128:129], v[76:77], v[112:113], v[128:129]
    v_pk_fma_f32 v[128:129], v[72:73], v[116:117], v[128:129]
    v_pk_fma_f32 v[128:129], v[68:69], v[120:121], v[128:129]
    v_pk_mul_f32 v[128:129], v[128:129], v[156:157]
    v_pk_mul_f32 v[130:131], v[82:83], v[110:111]
    v_pk_fma_f32 v[130:131], v[78:79], v[114:115], v[130:131]
    v_pk_fma_f32 v[130:131], v[74:75], v[118:119], v[130:131]
    v_pk_fma_f32 v[130:131], v[70:71], v[122:123], v[130:131]
    v_pk_mul_f32 v[130:131], v[130:131], v[158:159]
    s_cbranch_scc1 L_wv_19
    s_waitcnt vmcnt(5)
L_wv_19:
    s_waitcnt vmcnt(7)
    v_lshlrev_b32 v156, 16, v42
    v_and_b32 v157, s50, v42
    v_lshlrev_b32 v158, 16, v43
    v_and_b32 v159, s50, v43
    v_pk_mul_f32 v[132:133], v[84:85], v[108:109]
    v_pk_fma_f32 v[132:133], v[80:81], v[112:113], v[132:133]
    v_pk_fma_f32 v[132:133], v[76:77], v[116:117], v[132:133]
    v_pk_fma_f32 v[132:133], v[72:73], v[120:121], v[132:133]
    v_pk_mul_f32 v[132:133], v[132:133], v[156:157]
    v_pk_mul_f32 v[134:135], v[86:87], v[110:111]
    v_pk_fma_f32 v[134:135], v[82:83], v[114:115], v[134:135]
    v_pk_fma_f32 v[134:135], v[78:79], v[118:119], v[134:135]
    v_pk_fma_f32 v[134:135], v[74:75], v[122:123], v[134:135]
    v_pk_mul_f32 v[134:135], v[134:135], v[158:159]
    s_cbranch_scc1 L_wv_20
    s_waitcnt vmcnt(4)
L_wv_20:
    s_waitcnt vmcnt(6)
    v_lshlrev_b32 v156, 16, v44
    v_and_b32 v157, s50, v44
    v_lshlrev_b32 v158, 16, v45
    v_and_b32 v159, s50, v45
    v_pk_mul_f32 v[136:137], v[88:89], v[108:109]
    v_pk_fma_f32 v[136:137], v[84:85], v[112:113], v[136:137]
    v_pk_fma_f32 v[136:137], v[80:81], v[116:117], v[136:137]
    v_pk_fma_f32 v[136:137], v[76:77], v[120:121], v[136:137]
    v_pk_mul_f32 v[136:137], v[136:137], v[156:157]
    v_pk_mul_f32 v[138:139], v[90:91], v[110:111]
    v_pk_fma_f32 v[138:139], v[86:87], v[114:115], v[138:139]
    v_pk_fma_f32 v[138:139], v[82:83], v[118:119], v[138:139]
    v_pk_fma_f32 v[138:139], v[78:79], v[122:123], v[138:139]
    v_pk_mul_f32 v[138:139], v[138:139], v[158:159]
    s_cbranch_scc1 L_wv_21
    s_waitcnt vmcnt(3)
L_wv_21:
    s_waitcnt vmcnt(5)
    v_lshlrev_b32 v156, 16, v46
    v_and_b32 v157, s50, v46
    v_lshlrev_b32 v158, 16, v47
    v_and_b32 v159, s50, v47
    v_pk_mul_f32 v[140:141], v[92:93], v[108:109]
    v_pk_fma_f32 v[140:141], v[88:89], v[112:113], v[140:141]
    v_pk_fma_f32 v[140:141], v[84:85], v[116:117], v[140:141]
    v_pk_fma_f32 v[140:141], v[80:81], v[120:121], v[140:141]
    v_pk_mul_f32 v[140:141], v[140:141], v[156:157]
    v_pk_mul_f32 v[142:143], v[94:95], v[110:111]
    v_pk_fma_f32 v[142:143], v[90:91], v[114:115], v[142:143]
    v_pk_fma_f32 v[142:143], v[86:87], v[118:119], v[142:143]
    v_pk_fma_f32 v[142:143], v[82:83], v[122:123], v[142:143]
    v_pk_mul_f32 v[142:143], v[142:143], v[158:159]
    s_cbranch_scc1 L_wv_22
    s_waitcnt vmcnt(2)
L_wv_22:
    s_waitcnt vmcnt(4)
    v_lshlrev_b32 v156, 16, v48
    v_and_b32 v157, s50, v48
    v_lshlrev_b32 v158, 16, v49
    v_and_b32 v159, s50, v49
    v_pk_mul_f32 v[144:145], v[96:97], v[108:109]
    v_pk_fma_f32 v[144:145], v[92:93], v[112:113], v[144:145]
    v_pk_fma_f32 v[144:145], v[88:89], v[116:117], v[144:145]
    v_pk_fma_f32 v[144:145], v[84:85], v[120:121], v[144:145]
    v_pk_mul_f32 v[144:145], v[144:145], v[156:157]
    v_pk_mul_f32 v[146:147], v[98:99], v[110:111]
    v_pk_fma_f32 v[146:147], v[94:95], v[114:115], v[146:147]
    v_pk_fma_f32 v[146:147], v[90:91], v[118:119], v[146:147]
    v_pk_fma_f32 v[146:147], v[86:87], v[122:123], v[146:147]
    v_pk_mul_f32 v[146:147], v[146:147], v[158:159]
    s_cbranch_scc1 L_wv_23
    s_waitcnt vmcnt(1)
L_wv_23:
    s_waitcnt vmcnt(3)
    v_lshlrev_b32 v156, 16, v50
    v_and_b32 v157, s50, v50
    v_lshlrev_b32 v158, 16, v51
    v_and_b32 v159, s50, v51
    v_pk_mul_f32 v[148:149], v[100:101], v[108:109]
    v_pk_fma_f32 v[148:149], v[96:97], v[112:113], v[148:149]
    v_pk_fma_f32 v[148:149], v[92:93], v[116:117], v[148:149]
    v_pk_fma_f32 v[148:149], v[88:89], v[120:121], v[148:149]
    v_pk_mul_f32 v[148:149], v[148:149], v[156:157]
    v_pk_mul_f32 v[150:151], v[102:103], v[110:111]
    v_pk_fma_f32 v[150:151], v[98:99], v[114:115], v[150:151]
    v_pk_fma_f32 v[150:151], v[94:95], v[118:119], v[150:151]
    v_pk_fma_f32 v[150:151], v[90:91], v[122:123], v[150:151]
    v_pk_mul_f32 v[150:151], v[150:151], v[158:159]
    s_cbranch_scc1 L_wv_24
    s_waitcnt vmcnt(0)
L_wv_24:
    s_waitcnt vmcnt(2)
    v_lshlrev_b32 v156, 16, v52
    v_and_b32 v157, s50, v52
    v_lshlrev_b32 v158, 16, v53
    v_and_b32 v159, s50, v53
    v_pk_mul_f32 v[152:153], v[104:105], v[108:109]
    v_pk_fma_f32 v[152:153], v[100:101], v[112:113], v[152:153]
    v_pk_fma_f32 v[152:153], v[96:97], v[116:117], v[152:153]
    v_pk_fma_f32 v[152:153], v[92:93], v[120:121], v[152:153]
    v_pk_mul_f32 v[152:153], v[152:153], v[156:157]
    v_pk_mul_f32 v[154:155], v[106:107], v[110:111]
    v_pk_fma_f32 v[154:155], v[102:103], v[114:115], v[154:155]
    v_pk_fma_f32 v[154:155], v[98:99], v[118:119], v[154:155]
    v_pk_fma_f32 v[154:155], v[94:95], v[122:123], v[154:155]
    v_pk_mul_f32 v[154:155], v[154:155], v[158:159]
    v_cvt_pk_bf16_f32 v16, v152, v148
    v_cvt_pk_bf16_f32 v17, v144, v140
    v_cvt_pk_bf16_f32 v18, v136, v132
    v_cvt_pk_bf16_f32 v19, v128, v124
    v_cvt_pk_bf16_f32 v20, v153, v149
    v_cvt_pk_bf16_f32 v21, v145, v141
    v_cvt_pk_bf16_f32 v22, v137, v133
    v_cvt_pk_bf16_f32 v23, v129, v125
    v_cvt_pk_bf16_f32 v24, v154, v150
    v_cvt_pk_bf16_f32 v25, v146, v142
    v_cvt_pk_bf16_f32 v26, v138, v134
    v_cvt_pk_bf16_f32 v27, v130, v126
    v_cvt_pk_bf16_f32 v28, v155, v151
    v_cvt_pk_bf16_f32 v29, v147, v143
    v_cvt_pk_bf16_f32 v30, v139, v135
    v_cvt_pk_bf16_f32 v31, v131, v127
    buffer_store_dwordx4 v[16:19], v8, s[64:67], 0 offen
    buffer_store_dwordx4 v[20:23], v8, s[64:67], s32 offen
    buffer_store_dwordx4 v[24:27], v8, s[64:67], s33 offen
    buffer_store_dwordx4 v[28:31], v8, s[64:67], s34 offen
    s_lshl_b32 s51, s89, 4
    s_add_u32 s51, s51, s90
    s_lshl_b32 s51, s51, 6
    s_add_u32 s92, s51, 36864
    s_waitcnt vmcnt(0)
    s_barrier
    s_cmp_lg_u32 s3, 0
    s_cbranch_scc1 L_siga_25
    v_mov_b32 v14, s92
    v_mov_b32 v15, s101
    s_mov_b64 exec, 1
    buffer_store_dword v15, v14, s[28:31], 0 offen
    s_mov_b64 exec, -1
L_siga_25:
    s_cmp_lg_u32 s3, 0
    s_cbranch_scc1 L_locs_28
    s_mov_b32 s92, 0
    s_waitcnt vmcnt(1)
L_locp_26:
    v_xor_b32 v12, s0, v11
    v_lshrrev_b32 v13, 4, v12
    s_add_u32 s92, s92, 1
    v_cmp_ne_u32 vcc, 0, v13
    s_cbranch_vccz L_locd_27
    s_cmp_ge_u32 s92, 400000
    s_cbranch_scc1 L_locd_27
    buffer_load_dword v11, v10, s[28:31], 0 offen sc1
    s_waitcnt vmcnt(0)
    s_branch L_locp_26
L_locd_27:
    v_cmp_ne_u32 vcc, 0, v12
    s_nop 3
    s_cmp_eq_u64 vcc, 0
    s_cselect_b32 s93, 1, 0
    s_mov_b32 s79, s93
    v_mov_b32 v12, 53244
    v_mov_b32 v13, s93
    ds_write_b32 v12, v13
    s_waitcnt lgkmcnt(0)
L_locs_28:
    s_barrier
    v_mov_b32 v12, 53244
    ds_read_b32 v13, v12
    s_waitcnt lgkmcnt(0)
    v_readfirstlane_b32 s79, v13
    s_nop 3
    s_cmp_lg_u32 s79, 0
    s_cbranch_scc1 L_opt_29
    s_waitcnt vmcnt(0)
    buffer_store_dwordx4 v[16:19], v8, s[64:67], 0 offen sc1
    buffer_store_dwordx4 v[20:23], v8, s[64:67], s32 offen sc1
    buffer_store_dwordx4 v[24:27], v8, s[64:67], s33 offen sc1
    buffer_store_dwordx4 v[28:31], v8, s[64:67], s34 offen sc1
    s_add_u32 s51, s51, 102400
    s_waitcnt vmcnt(0)
    s_barrier
    s_cmp_lg_u32 s3, 0
    s_cbranch_scc1 L_sig_30
    v_mov_b32 v14, s51
    v_mov_b32 v15, s101
    s_mov_b64 exec, 1
    buffer_store_dword v15, v14, s[28:31], 0 offen sc1
    s_mov_b64 exec, -1
L_sig_30:
L_opt_29:
L_bsetup_2:
    s_setprio 0
    s_add_u32 s73, s46, 65536
    s_cmp_lg_u32 s79, 0
    s_cselect_b32 s46, s46, s73
    v_and_b32 v12, 15, v1
    v_lshlrev_b32 v12, 6, v12
    v_add_u32 v12, s46, v12
    s_cmp_lg_u32 s3, 0
    s_cbranch_scc1 L_pm0_31
    buffer_load_dword v13, v12, s[28:31], 0 offen sc1
L_pm0_31:
    v_lshlrev_b32 v235, 4, v1
    s_add_u32 s74, s44, 32
    s_mov_b32 m0, s74
    s_nop 0
    buffer_load_dwordx4 v235, s[80:83], s43 offen offset:0 nt lds
    buffer_load_dwordx4 v235, s[80:83], s43 offen offset:1024 nt lds
    buffer_load_dwordx4 v235, s[80:83], s43 offen offset:2048 nt lds
    buffer_load_dwordx4 v235, s[80:83], s43 offen offset:3072 nt lds
    s_cmp_lg_u32 s3, 0
    s_cbranch_scc1 L_pms_33
    s_mov_b32 s73, 0
    s_waitcnt vmcnt(4)
L_pml_32:
    v_xor_b32 v13, s101, v13
    v_cmp_ne_u32 vcc, 0, v13
    s_cbranch_vccz L_pms_33
    s_add_u32 s73, s73, 1
    s_cmp_ge_u32 s73, 400000
    s_cbranch_scc1 L_pms_33
    buffer_load_dword v13, v12, s[28:31], 0 offen sc1
    s_waitcnt vmcnt(0)
    s_branch L_pml_32
L_pms_33:
    s_barrier
    s_waitcnt lgkmcnt(0)
    s_and_b32 s73, s42, 1
    s_lshl_b32 s74, s45, 16
    s_and_b32 s75, s45, 0xffff0000
    s_cmp_eq_u32 s73, 1
    s_cselect_b32 s45, s75, s74
    v_mov_b32 v14, 53244
    ds_read_b32 v15, v14
    s_waitcnt lgkmcnt(0)
    v_readfirstlane_b32 s79, v15
    buffer_load_dwordx4 v[148:151], v242, s[84:87], s36 offen nt
    buffer_load_dwordx4 v[152:155], v242, s[84:87], s37 offen nt
    buffer_load_dwordx4 v[156:159], v242, s[84:87], s38 offen nt
    buffer_load_dwordx4 v[160:163], v242, s[84:87], s39 offen nt
    s_waitcnt vmcnt(4)
    v_lshlrev_b32 v233, 4, v1
    v_add_u32 v233, s44, v233
    ds_read_b128 v[20:23], v233 offset:32
    ds_read_b32 v36, v233 offset:48
    ds_read_b128 v[24:27], v233 offset:1056
    ds_read_b32 v37, v233 offset:1072
    ds_read_b128 v[28:31], v233 offset:2080
    ds_read_b32 v38, v233 offset:2096
    ds_read_b128 v[32:35], v233 offset:3104
    ds_read_b32 v39, v233 offset:3120
    v_mov_b32 v234, s44
    ds_read_b32 v230, v234 offset:32
    s_waitcnt lgkmcnt(0)
    v_alignbit_b32 v20, v21, v20, 16
    v_alignbit_b32 v21, v22, v21, 16
    v_alignbit_b32 v22, v23, v22, 16
    v_alignbit_b32 v23, v36, v23, 16
    ds_write_b128 v233, v[20:23] offset:4192
    v_alignbit_b32 v24, v25, v24, 16
    v_alignbit_b32 v25, v26, v25, 16
    v_alignbit_b32 v26, v27, v26, 16
    v_alignbit_b32 v27, v37, v27, 16
    ds_write_b128 v233, v[24:27] offset:5216
    v_alignbit_b32 v28, v29, v28, 16
    v_alignbit_b32 v29, v30, v29, 16
    v_alignbit_b32 v30, v31, v30, 16
    v_alignbit_b32 v31, v38, v31, 16
    ds_write_b128 v233, v[28:31] offset:6240
    v_alignbit_b32 v32, v33, v32, 16
    v_alignbit_b32 v33, v34, v33, 16
    v_alignbit_b32 v34, v35, v34, 16
    v_alignbit_b32 v35, v39, v35, 16
    ds_write_b128 v233, v[32:35] offset:7264
    v_lshlrev_b32 v230, 16, v230
    v_mov_b32 v234, 0
    v_cmp_eq_u32 vcc, 15, v1
    s_nop 1
    v_cndmask_b32 v230, v234, v230, vcc
    ds_write_b32 v231, v230
    s_waitcnt lgkmcnt(0)
    ds_read2_b32 v[52:53], v236 offset0:8 offset1:9
    ds_read2_b32 v[54:55], v236 offset0:10 offset1:11
    ds_read2_b32 v[56:57], v236 offset0:136 offset1:137
    ds_read2_b32 v[58:59], v236 offset0:138 offset1:139
    ds_read2_b32 v[60:61], v237 offset0:8 offset1:9
    ds_read2_b32 v[62:63], v237 offset0:10 offset1:11
    ds_read2_b32 v[64:65], v237 offset0:136 offset1:137
    ds_read2_b32 v[66:67], v237 offset0:138 offset1:139
    ds_read2_b32 v[68:69], v238 offset0:8 offset1:9
    ds_read2_b32 v[70:71], v238 offset0:10 offset1:11
    ds_read2_b32 v[72:73], v238 offset0:136 offset1:137
    ds_read2_b32 v[74:75], v238 offset0:138 offset1:139
    ds_read2_b32 v[76:77], v239 offset0:8 offset1:9
    ds_read2_b32 v[78:79], v239 offset0:10 offset1:11
    ds_read2_b32 v[80:81], v239 offset0:136 offset1:137
    ds_read2_b32 v[82:83], v239 offset0:138 offset1:139
    s_waitcnt vmcnt(3)
    ds_write_b128 v243, v[148:151] offset:0
    s_waitcnt vmcnt(2)
    ds_write_b128 v243, v[152:155] offset:1024
    s_waitcnt vmcnt(1)
    ds_write_b128 v243, v[156:159] offset:2048
    s_waitcnt vmcnt(0)
    ds_write_b128 v243, v[160:163] offset:3072
    s_waitcnt lgkmcnt(0)
    ds_read_b128 v[84:87], v240 offset:448
    ds_read_b128 v[88:91], v240 offset:960
    ds_read_b128 v[92:95], v240 offset:1472
    ds_read_b128 v[96:99], v240 offset:1984
    ds_read_b128 v[100:103], v240 offset:2496
    ds_read_b128 v[104:107], v240 offset:3008
    ds_read_b128 v[108:111], v240 offset:3520
    ds_read_b128 v[112:115], v240 offset:4032
    s_mov_b32 s89, s40
    s_mov_b32 s90, s41
    s_waitcnt lgkmcnt(0)
    v_mfma_f32_16x16x32_bf16 v[20:23], v[52:55], v[84:87], 0
    ds_read2_b32 v[116:117], v236 offset0:24 offset1:25
    v_mfma_f32_16x16x32_bf16 v[24:27], v[52:55], v[88:91], 0
    ds_read2_b32 v[118:119], v236 offset0:26 offset1:27
    v_mfma_f32_16x16x32_bf16 v[28:31], v[52:55], v[92:95], 0
    ds_read_b128 v[148:151], v240 offset:384
    v_mfma_f32_16x16x32_bf16 v[32:35], v[52:55], v[96:99], 0
    ds_read_b128 v[152:155], v240 offset:896
    v_mfma_f32_16x16x32_bf16 v[36:39], v[52:55], v[100:103], 0
    ds_read_b128 v[156:159], v240 offset:1408
    v_mfma_f32_16x16x32_bf16 v[40:43], v[52:55], v[104:107], 0
    ds_read_b128 v[160:163], v240 offset:1920
    v_mfma_f32_16x16x32_bf16 v[44:47], v[52:55], v[108:111], 0
    ds_read_b128 v[164:167], v240 offset:2432
    v_mfma_f32_16x16x32_bf16 v[48:51], v[52:55], v[112:115], 0
    ds_read_b128 v[168:171], v240 offset:2944
    v_mfma_f32_16x16x32_bf16 v[24:27], v[56:59], v[84:87], v[24:27]
    ds_read_b128 v[172:175], v240 offset:3456
    v_mfma_f32_16x16x32_bf16 v[28:31], v[56:59], v[88:91], v[28:31]
    ds_read_b128 v[176:179], v240 offset:3968
    v_mfma_f32_16x16x32_bf16 v[32:35], v[56:59], v[92:95], v[32:35]
    ds_read2_b32 v[120:121], v236 offset0:152 offset1:153
    v_mfma_f32_16x16x32_bf16 v[36:39], v[56:59], v[96:99], v[36:39]
    ds_read2_b32 v[122:123], v236 offset0:154 offset1:155
    v_mfma_f32_16x16x32_bf16 v[40:43], v[56:59], v[100:103], v[40:43]
    ds_read2_b32 v[124:125], v237 offset0:24 offset1:25
    v_mfma_f32_16x16x32_bf16 v[44:47], v[56:59], v[104:107], v[44:47]
    ds_read2_b32 v[126:127], v237 offset0:26 offset1:27
    v_mfma_f32_16x16x32_bf16 v[48:51], v[56:59], v[108:111], v[48:51]
    ds_read2_b32 v[128:129], v237 offset0:152 offset1:153
    v_mfma_f32_16x16x32_bf16 v[28:31], v[60:63], v[84:87], v[28:31]
    ds_read2_b32 v[130:131], v237 offset0:154 offset1:155
    v_mfma_f32_16x16x32_bf16 v[32:35], v[60:63], v[88:91], v[32:35]
    ds_read2_b32 v[132:133], v238 offset0:24 offset1:25
    v_mfma_f32_16x16x32_bf16 v[36:39], v[60:63], v[92:95], v[36:39]
    ds_read2_b32 v[134:135], v238 offset0:26 offset1:27
    v_mfma_f32_16x16x32_bf16 v[40:43], v[60:63], v[96:99], v[40:43]
    ds_read2_b32 v[136:137], v238 offset0:152 offset1:153
    v_mfma_f32_16x16x32_bf16 v[44:47], v[60:63], v[100:103], v[44:47]
    ds_read2_b32 v[138:139], v238 offset0:154 offset1:155
    v_mfma_f32_16x16x32_bf16 v[48:51], v[60:63], v[104:107], v[48:51]
    ds_read2_b32 v[140:141], v239 offset0:24 offset1:25
    v_mfma_f32_16x16x32_bf16 v[32:35], v[64:67], v[84:87], v[32:35]
    ds_read2_b32 v[142:143], v239 offset0:26 offset1:27
    v_mfma_f32_16x16x32_bf16 v[36:39], v[64:67], v[88:91], v[36:39]
    ds_read2_b32 v[144:145], v239 offset0:152 offset1:153
    v_mfma_f32_16x16x32_bf16 v[40:43], v[64:67], v[92:95], v[40:43]
    ds_read2_b32 v[146:147], v239 offset0:154 offset1:155
    v_mfma_f32_16x16x32_bf16 v[44:47], v[64:67], v[96:99], v[44:47]
    v_mfma_f32_16x16x32_bf16 v[48:51], v[64:67], v[100:103], v[48:51]
    v_mfma_f32_16x16x32_bf16 v[36:39], v[68:71], v[84:87], v[36:39]
    v_mfma_f32_16x16x32_bf16 v[40:43], v[68:71], v[88:91], v[40:43]
    v_mfma_f32_16x16x32_bf16 v[44:47], v[68:71], v[92:95], v[44:47]
    v_mfma_f32_16x16x32_bf16 v[48:51], v[68:71], v[96:99], v[48:51]
    v_mfma_f32_16x16x32_bf16 v[40:43], v[72:75], v[84:87], v[40:43]
    v_mfma_f32_16x16x32_bf16 v[44:47], v[72:75], v[88:91], v[44:47]
    v_mfma_f32_16x16x32_bf16 v[48:51], v[72:75], v[92:95], v[48:51]
    v_mfma_f32_16x16x32_bf16 v[44:47], v[76:79], v[84:87], v[44:47]
    v_mfma_f32_16x16x32_bf16 v[48:51], v[76:79], v[88:91], v[48:51]
    v_mfma_f32_16x16x32_bf16 v[48:51], v[80:83], v[84:87], v[48:51]
    s_waitcnt lgkmcnt(0)
    v_mfma_f32_16x16x32_bf16 v[20:23], v[116:119], v[148:151], v[20:23]
    ds_read2_b32 v[52:53], v236 offset0:40 offset1:41
    v_mfma_f32_16x16x32_bf16 v[24:27], v[116:119], v[152:155], v[24:27]
    ds_read2_b32 v[54:55], v236 offset0:42 offset1:43
    v_mfma_f32_16x16x32_bf16 v[28:31], v[116:119], v[156:159], v[28:31]
    ds_read_b128 v[84:87], v240 offset:320
    v_mfma_f32_16x16x32_bf16 v[32:35], v[116:119], v[160:163], v[32:35]
    ds_read_b128 v[88:91], v240 offset:832
    v_mfma_f32_16x16x32_bf16 v[36:39], v[116:119], v[164:167], v[36:39]
    ds_read_b128 v[92:95], v240 offset:1344
    v_mfma_f32_16x16x32_bf16 v[40:43], v[116:119], v[168:171], v[40:43]
    ds_read_b128 v[96:99], v240 offset:1856
    v_mfma_f32_16x16x32_bf16 v[44:47], v[116:119], v[172:175], v[44:47]
    ds_read_b128 v[100:103], v240 offset:2368
    v_mfma_f32_16x16x32_bf16 v[48:51], v[116:119], v[176:179], v[48:51]
    ds_read_b128 v[104:107], v240 offset:2880
    v_mfma_f32_16x16x32_bf16 v[24:27], v[120:123], v[148:151], v[24:27]
    ds_read_b128 v[108:111], v240 offset:3392
    v_mfma_f32_16x16x32_bf16 v[28:31], v[120:123], v[152:155], v[28:31]
    ds_read_b128 v[112:115], v240 offset:3904
    v_mfma_f32_16x16x32_bf16 v[32:35], v[120:123], v[156:159], v[32:35]
    ds_read2_b32 v[56:57], v236 offset0:168 offset1:169
    v_mfma_f32_16x16x32_bf16 v[36:39], v[120:123], v[160:163], v[36:39]
    ds_read2_b32 v[58:59], v236 offset0:170 offset1:171
    v_mfma_f32_16x16x32_bf16 v[40:43], v[120:123], v[164:167], v[40:43]
    ds_read2_b32 v[60:61], v237 offset0:40 offset1:41
    v_mfma_f32_16x16x32_bf16 v[44:47], v[120:123], v[168:171], v[44:47]
    ds_read2_b32 v[62:63], v237 offset0:42 offset1:43
    v_mfma_f32_16x16x32_bf16 v[48:51], v[120:123], v[172:175], v[48:51]
    ds_read2_b32 v[64:65], v237 offset0:168 offset1:169
    v_mfma_f32_16x16x32_bf16 v[28:31], v[124:127], v[148:151], v[28:31]
    ds_read2_b32 v[66:67], v237 offset0:170 offset1:171
    v_mfma_f32_16x16x32_bf16 v[32:35], v[124:127], v[152:155], v[32:35]
    ds_read2_b32 v[68:69], v238 offset0:40 offset1:41
    v_mfma_f32_16x16x32_bf16 v[36:39], v[124:127], v[156:159], v[36:39]
    ds_read2_b32 v[70:71], v238 offset0:42 offset1:43
    v_mfma_f32_16x16x32_bf16 v[40:43], v[124:127], v[160:163], v[40:43]
    ds_read2_b32 v[72:73], v238 offset0:168 offset1:169
    v_mfma_f32_16x16x32_bf16 v[44:47], v[124:127], v[164:167], v[44:47]
    ds_read2_b32 v[74:75], v238 offset0:170 offset1:171
    v_mfma_f32_16x16x32_bf16 v[48:51], v[124:127], v[168:171], v[48:51]
    ds_read2_b32 v[76:77], v239 offset0:40 offset1:41
    v_mfma_f32_16x16x32_bf16 v[32:35], v[128:131], v[148:151], v[32:35]
    ds_read2_b32 v[78:79], v239 offset0:42 offset1:43
    v_mfma_f32_16x16x32_bf16 v[36:39], v[128:131], v[152:155], v[36:39]
    ds_read2_b32 v[80:81], v239 offset0:168 offset1:169
    v_mfma_f32_16x16x32_bf16 v[40:43], v[128:131], v[156:159], v[40:43]
    ds_read2_b32 v[82:83], v239 offset0:170 offset1:171
    v_mfma_f32_16x16x32_bf16 v[44:47], v[128:131], v[160:163], v[44:47]
    v_mfma_f32_16x16x32_bf16 v[48:51], v[128:131], v[164:167], v[48:51]
    v_mfma_f32_16x16x32_bf16 v[36:39], v[132:135], v[148:151], v[36:39]
    v_mfma_f32_16x16x32_bf16 v[40:43], v[132:135], v[152:155], v[40:43]
    v_mfma_f32_16x16x32_bf16 v[44:47], v[132:135], v[156:159], v[44:47]
    v_mfma_f32_16x16x32_bf16 v[48:51], v[132:135], v[160:163], v[48:51]
    v_mfma_f32_16x16x32_bf16 v[40:43], v[136:139], v[148:151], v[40:43]
    v_mfma_f32_16x16x32_bf16 v[44:47], v[136:139], v[152:155], v[44:47]
    v_mfma_f32_16x16x32_bf16 v[48:51], v[136:139], v[156:159], v[48:51]
    v_mfma_f32_16x16x32_bf16 v[44:47], v[140:143], v[148:151], v[44:47]
    v_mfma_f32_16x16x32_bf16 v[48:51], v[140:143], v[152:155], v[48:51]
    v_mfma_f32_16x16x32_bf16 v[48:51], v[144:147], v[148:151], v[48:51]
    s_waitcnt lgkmcnt(0)
    v_mfma_f32_16x16x32_bf16 v[20:23], v[52:55], v[84:87], v[20:23]
    ds_read2_b32 v[116:117], v236 offset0:56 offset1:57
    v_mfma_f32_16x16x32_bf16 v[24:27], v[52:55], v[88:91], v[24:27]
    ds_read2_b32 v[118:119], v236 offset0:58 offset1:59
    v_mfma_f32_16x16x32_bf16 v[28:31], v[52:55], v[92:95], v[28:31]
    ds_read_b128 v[148:151], v240 offset:256
    v_mfma_f32_16x16x32_bf16 v[32:35], v[52:55], v[96:99], v[32:35]
    ds_read_b128 v[152:155], v240 offset:768
    v_mfma_f32_16x16x32_bf16 v[36:39], v[52:55], v[100:103], v[36:39]
    ds_read_b128 v[156:159], v240 offset:1280
    v_mfma_f32_16x16x32_bf16 v[40:43], v[52:55], v[104:107], v[40:43]
    ds_read_b128 v[160:163], v240 offset:1792
    v_mfma_f32_16x16x32_bf16 v[44:47], v[52:55], v[108:111], v[44:47]
    ds_read_b128 v[164:167], v240 offset:2304
    v_mfma_f32_16x16x32_bf16 v[48:51], v[52:55], v[112:115], v[48:51]
    ds_read_b128 v[168:171], v240 offset:2816
    v_mfma_f32_16x16x32_bf16 v[24:27], v[56:59], v[84:87], v[24:27]
    ds_read_b128 v[172:175], v240 offset:3328
    v_mfma_f32_16x16x32_bf16 v[28:31], v[56:59], v[88:91], v[28:31]
    ds_read_b128 v[176:179], v240 offset:3840
    v_mfma_f32_16x16x32_bf16 v[32:35], v[56:59], v[92:95], v[32:35]
    ds_read2_b32 v[120:121], v236 offset0:184 offset1:185
    v_mfma_f32_16x16x32_bf16 v[36:39], v[56:59], v[96:99], v[36:39]
    ds_read2_b32 v[122:123], v236 offset0:186 offset1:187
    v_mfma_f32_16x16x32_bf16 v[40:43], v[56:59], v[100:103], v[40:43]
    ds_read2_b32 v[124:125], v237 offset0:56 offset1:57
    v_mfma_f32_16x16x32_bf16 v[44:47], v[56:59], v[104:107], v[44:47]
    ds_read2_b32 v[126:127], v237 offset0:58 offset1:59
    v_mfma_f32_16x16x32_bf16 v[48:51], v[56:59], v[108:111], v[48:51]
    ds_read2_b32 v[128:129], v237 offset0:184 offset1:185
    v_mfma_f32_16x16x32_bf16 v[28:31], v[60:63], v[84:87], v[28:31]
    ds_read2_b32 v[130:131], v237 offset0:186 offset1:187
    v_mfma_f32_16x16x32_bf16 v[32:35], v[60:63], v[88:91], v[32:35]
    ds_read2_b32 v[132:133], v238 offset0:56 offset1:57
    v_mfma_f32_16x16x32_bf16 v[36:39], v[60:63], v[92:95], v[36:39]
    ds_read2_b32 v[134:135], v238 offset0:58 offset1:59
    v_mfma_f32_16x16x32_bf16 v[40:43], v[60:63], v[96:99], v[40:43]
    ds_read2_b32 v[136:137], v238 offset0:184 offset1:185
    v_mfma_f32_16x16x32_bf16 v[44:47], v[60:63], v[100:103], v[44:47]
    ds_read2_b32 v[138:139], v238 offset0:186 offset1:187
    v_mfma_f32_16x16x32_bf16 v[48:51], v[60:63], v[104:107], v[48:51]
    ds_read2_b32 v[140:141], v239 offset0:56 offset1:57
    v_mfma_f32_16x16x32_bf16 v[32:35], v[64:67], v[84:87], v[32:35]
    ds_read2_b32 v[142:143], v239 offset0:58 offset1:59
    v_mfma_f32_16x16x32_bf16 v[36:39], v[64:67], v[88:91], v[36:39]
    ds_read2_b32 v[144:145], v239 offset0:184 offset1:185
    v_mfma_f32_16x16x32_bf16 v[40:43], v[64:67], v[92:95], v[40:43]
    ds_read2_b32 v[146:147], v239 offset0:186 offset1:187
    v_mfma_f32_16x16x32_bf16 v[44:47], v[64:67], v[96:99], v[44:47]
    v_mfma_f32_16x16x32_bf16 v[48:51], v[64:67], v[100:103], v[48:51]
    v_mfma_f32_16x16x32_bf16 v[36:39], v[68:71], v[84:87], v[36:39]
    v_mfma_f32_16x16x32_bf16 v[40:43], v[68:71], v[88:91], v[40:43]
    v_mfma_f32_16x16x32_bf16 v[44:47], v[68:71], v[92:95], v[44:47]
    v_mfma_f32_16x16x32_bf16 v[48:51], v[68:71], v[96:99], v[48:51]
    v_mfma_f32_16x16x32_bf16 v[40:43], v[72:75], v[84:87], v[40:43]
    v_mfma_f32_16x16x32_bf16 v[44:47], v[72:75], v[88:91], v[44:47]
    v_mfma_f32_16x16x32_bf16 v[48:51], v[72:75], v[92:95], v[48:51]
    v_mfma_f32_16x16x32_bf16 v[44:47], v[76:79], v[84:87], v[44:47]
    v_mfma_f32_16x16x32_bf16 v[48:51], v[76:79], v[88:91], v[48:51]
    v_mfma_f32_16x16x32_bf16 v[48:51], v[80:83], v[84:87], v[48:51]
    s_waitcnt lgkmcnt(0)
    v_mfma_f32_16x16x32_bf16 v[20:23], v[116:119], v[148:151], v[20:23]
    ds_read2_b32 v[52:53], v236 offset0:72 offset1:73
    v_mfma_f32_16x16x32_bf16 v[24:27], v[116:119], v[152:155], v[24:27]
    ds_read2_b32 v[54:55], v236 offset0:74 offset1:75
    v_mfma_f32_16x16x32_bf16 v[28:31], v[116:119], v[156:159], v[28:31]
    ds_read_b128 v[84:87], v240 offset:192
    v_mfma_f32_16x16x32_bf16 v[32:35], v[116:119], v[160:163], v[32:35]
    ds_read_b128 v[88:91], v240 offset:704
    v_mfma_f32_16x16x32_bf16 v[36:39], v[116:119], v[164:167], v[36:39]
    ds_read_b128 v[92:95], v240 offset:1216
    v_mfma_f32_16x16x32_bf16 v[40:43], v[116:119], v[168:171], v[40:43]
    ds_read_b128 v[96:99], v240 offset:1728
    v_mfma_f32_16x16x32_bf16 v[44:47], v[116:119], v[172:175], v[44:47]
    ds_read_b128 v[100:103], v240 offset:2240
    v_mfma_f32_16x16x32_bf16 v[48:51], v[116:119], v[176:179], v[48:51]
    ds_read_b128 v[104:107], v240 offset:2752
    v_mfma_f32_16x16x32_bf16 v[24:27], v[120:123], v[148:151], v[24:27]
    ds_read_b128 v[108:111], v240 offset:3264
    v_mfma_f32_16x16x32_bf16 v[28:31], v[120:123], v[152:155], v[28:31]
    ds_read_b128 v[112:115], v240 offset:3776
    v_mfma_f32_16x16x32_bf16 v[32:35], v[120:123], v[156:159], v[32:35]
    ds_read2_b32 v[56:57], v236 offset0:200 offset1:201
    v_mfma_f32_16x16x32_bf16 v[36:39], v[120:123], v[160:163], v[36:39]
    ds_read2_b32 v[58:59], v236 offset0:202 offset1:203
    v_mfma_f32_16x16x32_bf16 v[40:43], v[120:123], v[164:167], v[40:43]
    ds_read2_b32 v[60:61], v237 offset0:72 offset1:73
    v_mfma_f32_16x16x32_bf16 v[44:47], v[120:123], v[168:171], v[44:47]
    ds_read2_b32 v[62:63], v237 offset0:74 offset1:75
    v_mfma_f32_16x16x32_bf16 v[48:51], v[120:123], v[172:175], v[48:51]
    ds_read2_b32 v[64:65], v237 offset0:200 offset1:201
    v_mfma_f32_16x16x32_bf16 v[28:31], v[124:127], v[148:151], v[28:31]
    ds_read2_b32 v[66:67], v237 offset0:202 offset1:203
    v_mfma_f32_16x16x32_bf16 v[32:35], v[124:127], v[152:155], v[32:35]
    ds_read2_b32 v[68:69], v238 offset0:72 offset1:73
    v_mfma_f32_16x16x32_bf16 v[36:39], v[124:127], v[156:159], v[36:39]
    ds_read2_b32 v[70:71], v238 offset0:74 offset1:75
    v_mfma_f32_16x16x32_bf16 v[40:43], v[124:127], v[160:163], v[40:43]
    ds_read2_b32 v[72:73], v238 offset0:200 offset1:201
    v_mfma_f32_16x16x32_bf16 v[44:47], v[124:127], v[164:167], v[44:47]
    ds_read2_b32 v[74:75], v238 offset0:202 offset1:203
    v_mfma_f32_16x16x32_bf16 v[48:51], v[124:127], v[168:171], v[48:51]
    ds_read2_b32 v[76:77], v239 offset0:72 offset1:73
    v_mfma_f32_16x16x32_bf16 v[32:35], v[128:131], v[148:151], v[32:35]
    ds_read2_b32 v[78:79], v239 offset0:74 offset1:75
    v_mfma_f32_16x16x32_bf16 v[36:39], v[128:131], v[152:155], v[36:39]
    ds_read2_b32 v[80:81], v239 offset0:200 offset1:201
    v_mfma_f32_16x16x32_bf16 v[40:43], v[128:131], v[156:159], v[40:43]
    ds_read2_b32 v[82:83], v239 offset0:202 offset1:203
    v_mfma_f32_16x16x32_bf16 v[44:47], v[128:131], v[160:163], v[44:47]
    v_mfma_f32_16x16x32_bf16 v[48:51], v[128:131], v[164:167], v[48:51]
    v_mfma_f32_16x16x32_bf16 v[36:39], v[132:135], v[148:151], v[36:39]
    v_mfma_f32_16x16x32_bf16 v[40:43], v[132:135], v[152:155], v[40:43]
    v_mfma_f32_16x16x32_bf16 v[44:47], v[132:135], v[156:159], v[44:47]
    v_mfma_f32_16x16x32_bf16 v[48:51], v[132:135], v[160:163], v[48:51]
    v_mfma_f32_16x16x32_bf16 v[40:43], v[136:139], v[148:151], v[40:43]
    v_mfma_f32_16x16x32_bf16 v[44:47], v[136:139], v[152:155], v[44:47]
    v_mfma_f32_16x16x32_bf16 v[48:51], v[136:139], v[156:159], v[48:51]
    v_mfma_f32_16x16x32_bf16 v[44:47], v[140:143], v[148:151], v[44:47]
    v_mfma_f32_16x16x32_bf16 v[48:51], v[140:143], v[152:155], v[48:51]
    v_mfma_f32_16x16x32_bf16 v[48:51], v[144:147], v[148:151], v[48:51]
    s_waitcnt lgkmcnt(0)
    v_mfma_f32_16x16x32_bf16 v[20:23], v[52:55], v[84:87], v[20:23]
    ds_read2_b32 v[116:117], v236 offset0:88 offset1:89
    v_mfma_f32_16x16x32_bf16 v[24:27], v[52:55], v[88:91], v[24:27]
    ds_read2_b32 v[118:119], v236 offset0:90 offset1:91
    v_mfma_f32_16x16x32_bf16 v[28:31], v[52:55], v[92:95], v[28:31]
    ds_read_b128 v[148:151], v240 offset:128
    v_mfma_f32_16x16x32_bf16 v[32:35], v[52:55], v[96:99], v[32:35]
    ds_read_b128 v[152:155], v240 offset:640
    v_mfma_f32_16x16x32_bf16 v[36:39], v[52:55], v[100:103], v[36:39]
    ds_read_b128 v[156:159], v240 offset:1152
    v_mfma_f32_16x16x32_bf16 v[40:43], v[52:55], v[104:107], v[40:43]
    ds_read_b128 v[160:163], v240 offset:1664
    v_mfma_f32_16x16x32_bf16 v[44:47], v[52:55], v[108:111], v[44:47]
    ds_read_b128 v[164:167], v240 offset:2176
    v_mfma_f32_16x16x32_bf16 v[48:51], v[52:55], v[112:115], v[48:51]
    ds_read_b128 v[168:171], v240 offset:2688
    v_mfma_f32_16x16x32_bf16 v[24:27], v[56:59], v[84:87], v[24:27]
    ds_read_b128 v[172:175], v240 offset:3200
    v_mfma_f32_16x16x32_bf16 v[28:31], v[56:59], v[88:91], v[28:31]
    ds_read_b128 v[176:179], v240 offset:3712
    v_mfma_f32_16x16x32_bf16 v[32:35], v[56:59], v[92:95], v[32:35]
    ds_read2_b32 v[120:121], v236 offset0:216 offset1:217
    v_mfma_f32_16x16x32_bf16 v[36:39], v[56:59], v[96:99], v[36:39]
    ds_read2_b32 v[122:123], v236 offset0:218 offset1:219
    v_mfma_f32_16x16x32_bf16 v[40:43], v[56:59], v[100:103], v[40:43]
    ds_read2_b32 v[124:125], v237 offset0:88 offset1:89
    v_mfma_f32_16x16x32_bf16 v[44:47], v[56:59], v[104:107], v[44:47]
    ds_read2_b32 v[126:127], v237 offset0:90 offset1:91
    v_mfma_f32_16x16x32_bf16 v[48:51], v[56:59], v[108:111], v[48:51]
    ds_read2_b32 v[128:129], v237 offset0:216 offset1:217
    v_mfma_f32_16x16x32_bf16 v[28:31], v[60:63], v[84:87], v[28:31]
    ds_read2_b32 v[130:131], v237 offset0:218 offset1:219
    v_mfma_f32_16x16x32_bf16 v[32:35], v[60:63], v[88:91], v[32:35]
    ds_read2_b32 v[132:133], v238 offset0:88 offset1:89
    v_mfma_f32_16x16x32_bf16 v[36:39], v[60:63], v[92:95], v[36:39]
    ds_read2_b32 v[134:135], v238 offset0:90 offset1:91
    v_mfma_f32_16x16x32_bf16 v[40:43], v[60:63], v[96:99], v[40:43]
    ds_read2_b32 v[136:137], v238 offset0:216 offset1:217
    v_mfma_f32_16x16x32_bf16 v[44:47], v[60:63], v[100:103], v[44:47]
    ds_read2_b32 v[138:139], v238 offset0:218 offset1:219
    v_mfma_f32_16x16x32_bf16 v[48:51], v[60:63], v[104:107], v[48:51]
    ds_read2_b32 v[140:141], v239 offset0:88 offset1:89
    v_mfma_f32_16x16x32_bf16 v[32:35], v[64:67], v[84:87], v[32:35]
    ds_read2_b32 v[142:143], v239 offset0:90 offset1:91
    v_mfma_f32_16x16x32_bf16 v[36:39], v[64:67], v[88:91], v[36:39]
    ds_read2_b32 v[144:145], v239 offset0:216 offset1:217
    v_mfma_f32_16x16x32_bf16 v[40:43], v[64:67], v[92:95], v[40:43]
    ds_read2_b32 v[146:147], v239 offset0:218 offset1:219
    v_mfma_f32_16x16x32_bf16 v[44:47], v[64:67], v[96:99], v[44:47]
    v_mfma_f32_16x16x32_bf16 v[48:51], v[64:67], v[100:103], v[48:51]
    v_mfma_f32_16x16x32_bf16 v[36:39], v[68:71], v[84:87], v[36:39]
    v_mfma_f32_16x16x32_bf16 v[40:43], v[68:71], v[88:91], v[40:43]
    v_mfma_f32_16x16x32_bf16 v[44:47], v[68:71], v[92:95], v[44:47]
    v_mfma_f32_16x16x32_bf16 v[48:51], v[68:71], v[96:99], v[48:51]
    v_mfma_f32_16x16x32_bf16 v[40:43], v[72:75], v[84:87], v[40:43]
    v_mfma_f32_16x16x32_bf16 v[44:47], v[72:75], v[88:91], v[44:47]
    v_mfma_f32_16x16x32_bf16 v[48:51], v[72:75], v[92:95], v[48:51]
    v_mfma_f32_16x16x32_bf16 v[44:47], v[76:79], v[84:87], v[44:47]
    v_mfma_f32_16x16x32_bf16 v[48:51], v[76:79], v[88:91], v[48:51]
    v_mfma_f32_16x16x32_bf16 v[48:51], v[80:83], v[84:87], v[48:51]
    s_waitcnt lgkmcnt(0)
    v_mfma_f32_16x16x32_bf16 v[20:23], v[116:119], v[148:151], v[20:23]
    ds_read2_b32 v[52:53], v236 offset0:104 offset1:105
    v_mfma_f32_16x16x32_bf16 v[24:27], v[116:119], v[152:155], v[24:27]
    ds_read2_b32 v[54:55], v236 offset0:106 offset1:107
    v_mfma_f32_16x16x32_bf16 v[28:31], v[116:119], v[156:159], v[28:31]
    ds_read_b128 v[84:87], v240 offset:64
    v_mfma_f32_16x16x32_bf16 v[32:35], v[116:119], v[160:163], v[32:35]
    ds_read_b128 v[88:91], v240 offset:576
    v_mfma_f32_16x16x32_bf16 v[36:39], v[116:119], v[164:167], v[36:39]
    ds_read_b128 v[92:95], v240 offset:1088
    v_mfma_f32_16x16x32_bf16 v[40:43], v[116:119], v[168:171], v[40:43]
    ds_read_b128 v[96:99], v240 offset:1600
    v_mfma_f32_16x16x32_bf16 v[44:47], v[116:119], v[172:175], v[44:47]
    ds_read_b128 v[100:103], v240 offset:2112
    v_mfma_f32_16x16x32_bf16 v[48:51], v[116:119], v[176:179], v[48:51]
    ds_read_b128 v[104:107], v240 offset:2624
    v_mfma_f32_16x16x32_bf16 v[24:27], v[120:123], v[148:151], v[24:27]
    ds_read_b128 v[108:111], v240 offset:3136
    v_mfma_f32_16x16x32_bf16 v[28:31], v[120:123], v[152:155], v[28:31]
    ds_read_b128 v[112:115], v240 offset:3648
    v_mfma_f32_16x16x32_bf16 v[32:35], v[120:123], v[156:159], v[32:35]
    ds_read2_b32 v[56:57], v236 offset0:232 offset1:233
    v_mfma_f32_16x16x32_bf16 v[36:39], v[120:123], v[160:163], v[36:39]
    ds_read2_b32 v[58:59], v236 offset0:234 offset1:235
    v_mfma_f32_16x16x32_bf16 v[40:43], v[120:123], v[164:167], v[40:43]
    ds_read2_b32 v[60:61], v237 offset0:104 offset1:105
    v_mfma_f32_16x16x32_bf16 v[44:47], v[120:123], v[168:171], v[44:47]
    ds_read2_b32 v[62:63], v237 offset0:106 offset1:107
    v_mfma_f32_16x16x32_bf16 v[48:51], v[120:123], v[172:175], v[48:51]
    ds_read2_b32 v[64:65], v237 offset0:232 offset1:233
    v_mfma_f32_16x16x32_bf16 v[28:31], v[124:127], v[148:151], v[28:31]
    ds_read2_b32 v[66:67], v237 offset0:234 offset1:235
    v_mfma_f32_16x16x32_bf16 v[32:35], v[124:127], v[152:155], v[32:35]
    ds_read2_b32 v[68:69], v238 offset0:104 offset1:105
    v_mfma_f32_16x16x32_bf16 v[36:39], v[124:127], v[156:159], v[36:39]
    ds_read2_b32 v[70:71], v238 offset0:106 offset1:107
    v_mfma_f32_16x16x32_bf16 v[40:43], v[124:127], v[160:163], v[40:43]
    ds_read2_b32 v[72:73], v238 offset0:232 offset1:233
    v_mfma_f32_16x16x32_bf16 v[44:47], v[124:127], v[164:167], v[44:47]
    ds_read2_b32 v[74:75], v238 offset0:234 offset1:235
    v_mfma_f32_16x16x32_bf16 v[48:51], v[124:127], v[168:171], v[48:51]
    ds_read2_b32 v[76:77], v239 offset0:104 offset1:105
    v_mfma_f32_16x16x32_bf16 v[32:35], v[128:131], v[148:151], v[32:35]
    ds_read2_b32 v[78:79], v239 offset0:106 offset1:107
    v_mfma_f32_16x16x32_bf16 v[36:39], v[128:131], v[152:155], v[36:39]
    ds_read2_b32 v[80:81], v239 offset0:232 offset1:233
    v_mfma_f32_16x16x32_bf16 v[40:43], v[128:131], v[156:159], v[40:43]
    ds_read2_b32 v[82:83], v239 offset0:234 offset1:235
    v_mfma_f32_16x16x32_bf16 v[44:47], v[128:131], v[160:163], v[44:47]
    v_mfma_f32_16x16x32_bf16 v[48:51], v[128:131], v[164:167], v[48:51]
    v_mfma_f32_16x16x32_bf16 v[36:39], v[132:135], v[148:151], v[36:39]
    v_mfma_f32_16x16x32_bf16 v[40:43], v[132:135], v[152:155], v[40:43]
    v_mfma_f32_16x16x32_bf16 v[44:47], v[132:135], v[156:159], v[44:47]
    v_mfma_f32_16x16x32_bf16 v[48:51], v[132:135], v[160:163], v[48:51]
    v_mfma_f32_16x16x32_bf16 v[40:43], v[136:139], v[148:151], v[40:43]
    v_mfma_f32_16x16x32_bf16 v[44:47], v[136:139], v[152:155], v[44:47]
    v_mfma_f32_16x16x32_bf16 v[48:51], v[136:139], v[156:159], v[48:51]
    v_mfma_f32_16x16x32_bf16 v[44:47], v[140:143], v[148:151], v[44:47]
    v_mfma_f32_16x16x32_bf16 v[48:51], v[140:143], v[152:155], v[48:51]
    v_mfma_f32_16x16x32_bf16 v[48:51], v[144:147], v[148:151], v[48:51]
    s_waitcnt lgkmcnt(0)
    v_mfma_f32_16x16x32_bf16 v[20:23], v[52:55], v[84:87], v[20:23]
    ds_read2_b32 v[116:117], v236 offset0:120 offset1:121
    v_mfma_f32_16x16x32_bf16 v[24:27], v[52:55], v[88:91], v[24:27]
    ds_read2_b32 v[118:119], v236 offset0:122 offset1:123
    v_mfma_f32_16x16x32_bf16 v[28:31], v[52:55], v[92:95], v[28:31]
    ds_read_b128 v[148:151], v240 offset:0
    v_mfma_f32_16x16x32_bf16 v[32:35], v[52:55], v[96:99], v[32:35]
    ds_read_b128 v[152:155], v240 offset:512
    v_mfma_f32_16x16x32_bf16 v[36:39], v[52:55], v[100:103], v[36:39]
    ds_read_b128 v[156:159], v240 offset:1024
    v_mfma_f32_16x16x32_bf16 v[40:43], v[52:55], v[104:107], v[40:43]
    ds_read_b128 v[160:163], v240 offset:1536
    v_mfma_f32_16x16x32_bf16 v[44:47], v[52:55], v[108:111], v[44:47]
    ds_read_b128 v[164:167], v240 offset:2048
    v_mfma_f32_16x16x32_bf16 v[48:51], v[52:55], v[112:115], v[48:51]
    ds_read_b128 v[168:171], v240 offset:2560
    v_mfma_f32_16x16x32_bf16 v[24:27], v[56:59], v[84:87], v[24:27]
    ds_read_b128 v[172:175], v240 offset:3072
    v_mfma_f32_16x16x32_bf16 v[28:31], v[56:59], v[88:91], v[28:31]
    ds_read_b128 v[176:179], v240 offset:3584
    v_mfma_f32_16x16x32_bf16 v[32:35], v[56:59], v[92:95], v[32:35]
    ds_read2_b32 v[120:121], v236 offset0:248 offset1:249
    v_mfma_f32_16x16x32_bf16 v[36:39], v[56:59], v[96:99], v[36:39]
    ds_read2_b32 v[122:123], v236 offset0:250 offset1:251
    v_mfma_f32_16x16x32_bf16 v[40:43], v[56:59], v[100:103], v[40:43]
    ds_read2_b32 v[124:125], v237 offset0:120 offset1:121
    v_mfma_f32_16x16x32_bf16 v[44:47], v[56:59], v[104:107], v[44:47]
    ds_read2_b32 v[126:127], v237 offset0:122 offset1:123
    v_mfma_f32_16x16x32_bf16 v[48:51], v[56:59], v[108:111], v[48:51]
    ds_read2_b32 v[128:129], v237 offset0:248 offset1:249
    v_mfma_f32_16x16x32_bf16 v[28:31], v[60:63], v[84:87], v[28:31]
    ds_read2_b32 v[130:131], v237 offset0:250 offset1:251
    v_mfma_f32_16x16x32_bf16 v[32:35], v[60:63], v[88:91], v[32:35]
    ds_read2_b32 v[132:133], v238 offset0:120 offset1:121
    v_mfma_f32_16x16x32_bf16 v[36:39], v[60:63], v[92:95], v[36:39]
    ds_read2_b32 v[134:135], v238 offset0:122 offset1:123
    v_mfma_f32_16x16x32_bf16 v[40:43], v[60:63], v[96:99], v[40:43]
    ds_read2_b32 v[136:137], v238 offset0:248 offset1:249
    v_mfma_f32_16x16x32_bf16 v[44:47], v[60:63], v[100:103], v[44:47]
    ds_read2_b32 v[138:139], v238 offset0:250 offset1:251
    v_mfma_f32_16x16x32_bf16 v[48:51], v[60:63], v[104:107], v[48:51]
    ds_read2_b32 v[140:141], v239 offset0:120 offset1:121
    v_mfma_f32_16x16x32_bf16 v[32:35], v[64:67], v[84:87], v[32:35]
    ds_read2_b32 v[142:143], v239 offset0:122 offset1:123
    v_mfma_f32_16x16x32_bf16 v[36:39], v[64:67], v[88:91], v[36:39]
    ds_read2_b32 v[144:145], v239 offset0:248 offset1:249
    v_mfma_f32_16x16x32_bf16 v[40:43], v[64:67], v[92:95], v[40:43]
    ds_read2_b32 v[146:147], v239 offset0:250 offset1:251
    v_mfma_f32_16x16x32_bf16 v[44:47], v[64:67], v[96:99], v[44:47]
    v_mfma_f32_16x16x32_bf16 v[48:51], v[64:67], v[100:103], v[48:51]
    v_mfma_f32_16x16x32_bf16 v[36:39], v[68:71], v[84:87], v[36:39]
    v_mfma_f32_16x16x32_bf16 v[40:43], v[68:71], v[88:91], v[40:43]
    v_mfma_f32_16x16x32_bf16 v[44:47], v[68:71], v[92:95], v[44:47]
    v_mfma_f32_16x16x32_bf16 v[48:51], v[68:71], v[96:99], v[48:51]
    v_mfma_f32_16x16x32_bf16 v[40:43], v[72:75], v[84:87], v[40:43]
    v_mfma_f32_16x16x32_bf16 v[44:47], v[72:75], v[88:91], v[44:47]
    v_mfma_f32_16x16x32_bf16 v[48:51], v[72:75], v[92:95], v[48:51]
    v_mfma_f32_16x16x32_bf16 v[44:47], v[76:79], v[84:87], v[44:47]
    v_mfma_f32_16x16x32_bf16 v[48:51], v[76:79], v[88:91], v[48:51]
    v_mfma_f32_16x16x32_bf16 v[48:51], v[80:83], v[84:87], v[48:51]
    s_waitcnt lgkmcnt(0)
    v_mfma_f32_16x16x32_bf16 v[20:23], v[116:119], v[148:151], v[20:23]
    ds_read_b64 v[52:53], v232 offset:0
    v_mfma_f32_16x16x32_bf16 v[24:27], v[116:119], v[152:155], v[24:27]
    ds_read_b64 v[54:55], v232 offset:512
    v_mfma_f32_16x16x32_bf16 v[28:31], v[116:119], v[156:159], v[28:31]
    ds_read_b64 v[56:57], v232 offset:1024
    v_mfma_f32_16x16x32_bf16 v[32:35], v[116:119], v[160:163], v[32:35]
    ds_read_b64 v[58:59], v232 offset:1536
    v_mfma_f32_16x16x32_bf16 v[36:39], v[116:119], v[164:167], v[36:39]
    ds_read_b64 v[60:61], v232 offset:2048
    v_mfma_f32_16x16x32_bf16 v[40:43], v[116:119], v[168:171], v[40:43]
    ds_read_b64 v[62:63], v232 offset:2560
    v_mfma_f32_16x16x32_bf16 v[44:47], v[116:119], v[172:175], v[44:47]
    ds_read_b64 v[64:65], v232 offset:3072
    v_mfma_f32_16x16x32_bf16 v[48:51], v[116:119], v[176:179], v[48:51]
    ds_read_b64 v[66:67], v232 offset:3584
    v_mfma_f32_16x16x32_bf16 v[24:27], v[120:123], v[148:151], v[24:27]
    v_mfma_f32_16x16x32_bf16 v[28:31], v[120:123], v[152:155], v[28:31]
    v_mfma_f32_16x16x32_bf16 v[32:35], v[120:123], v[156:159], v[32:35]
    v_mfma_f32_16x16x32_bf16 v[36:39], v[120:123], v[160:163], v[36:39]
    v_mfma_f32_16x16x32_bf16 v[40:43], v[120:123], v[164:167], v[40:43]
    v_mfma_f32_16x16x32_bf16 v[44:47], v[120:123], v[168:171], v[44:47]
    v_mfma_f32_16x16x32_bf16 v[48:51], v[120:123], v[172:175], v[48:51]
    v_mfma_f32_16x16x32_bf16 v[28:31], v[124:127], v[148:151], v[28:31]
    v_mfma_f32_16x16x32_bf16 v[32:35], v[124:127], v[152:155], v[32:35]
    v_mfma_f32_16x16x32_bf16 v[36:39], v[124:127], v[156:159], v[36:39]
    v_mfma_f32_16x16x32_bf16 v[40:43], v[124:127], v[160:163], v[40:43]
    v_mfma_f32_16x16x32_bf16 v[44:47], v[124:127], v[164:167], v[44:47]
    v_mfma_f32_16x16x32_bf16 v[48:51], v[124:127], v[168:171], v[48:51]
    v_mfma_f32_16x16x32_bf16 v[32:35], v[128:131], v[148:151], v[32:35]
    v_mfma_f32_16x16x32_bf16 v[36:39], v[128:131], v[152:155], v[36:39]
    v_mfma_f32_16x16x32_bf16 v[40:43], v[128:131], v[156:159], v[40:43]
    v_mfma_f32_16x16x32_bf16 v[44:47], v[128:131], v[160:163], v[44:47]
    v_mfma_f32_16x16x32_bf16 v[48:51], v[128:131], v[164:167], v[48:51]
    v_mfma_f32_16x16x32_bf16 v[36:39], v[132:135], v[148:151], v[36:39]
    v_mfma_f32_16x16x32_bf16 v[40:43], v[132:135], v[152:155], v[40:43]
    v_mfma_f32_16x16x32_bf16 v[44:47], v[132:135], v[156:159], v[44:47]
    v_mfma_f32_16x16x32_bf16 v[48:51], v[132:135], v[160:163], v[48:51]
    v_mfma_f32_16x16x32_bf16 v[40:43], v[136:139], v[148:151], v[40:43]
    v_mfma_f32_16x16x32_bf16 v[44:47], v[136:139], v[152:155], v[44:47]
    v_mfma_f32_16x16x32_bf16 v[48:51], v[136:139], v[156:159], v[48:51]
    v_mfma_f32_16x16x32_bf16 v[44:47], v[140:143], v[148:151], v[44:47]
    v_mfma_f32_16x16x32_bf16 v[48:51], v[140:143], v[152:155], v[48:51]
    v_mfma_f32_16x16x32_bf16 v[48:51], v[144:147], v[148:151], v[48:51]
    s_mov_b32 s52, s10
    s_mov_b32 s53, s11
    s_mov_b32 s54, 4194304
    s_mov_b32 s55, 0x00020000
    s_mov_b32 s60, s22
    s_mov_b32 s61, s23
    s_mov_b32 s62, 8388608
    s_mov_b32 s63, 0x00020000
    s_lshl_b32 s48, s90, 7
    s_lshl_b32 s51, s3, 5
    s_add_u32 s48, s48, s51
    s_lshl_b32 s49, s89, 6
    s_mov_b32 s68, 4096
    s_mov_b32 s69, 8192
    s_mov_b32 s70, 12288
    s_mov_b32 s71, 16384
    s_mov_b32 s76, 20480
    s_mov_b32 s77, 24576
    s_mov_b32 s78, 28672
    s_mov_b32 s50, 0xffff0000
    v_and_b32 v227, 15, v1
    v_lshrrev_b32 v228, 4, v1
    v_lshl_add_u32 v228, v228, 3, s48
    v_lshl_add_u32 v227, v227, 2, s49
    v_lshlrev_b32 v224, 11, v228
    v_lshl_add_u32 v224, v227, 1, v224
    v_lshlrev_b32 v226, 12, v228
    v_lshl_add_u32 v226, v227, 1, v226
    v_add_u32 v226, 2048, v226
    v_and_b32 v227, 15, v1
    v_lshrrev_b32 v228, 4, v1
    s_lshl_b32 s51, s90, 7
    s_lshl_b32 s92, s3, 5
    s_add_u32 s51, s51, s92
    s_lshl_b32 s51, s51, 12
    s_lshl_b32 s92, s89, 7
    s_add_u32 s51, s51, s92
    s_add_u32 s51, s51, 2048
    v_lshrrev_b32 v225, 1, v227
    v_lshlrev_b32 v225, 12, v225
    v_lshl_add_u32 v225, v228, 4, v225
    v_and_b32 v227, 1, v227
    v_lshl_add_u32 v225, v227, 6, v225
    v_add_u32 v225, s51, v225
    s_mov_b32 s32, 32768
    s_mov_b32 s33, 65536
    s_mov_b32 s34, 98304
    buffer_load_dwordx2 v[208:209], v224, s[52:55], 0 offen nt
    buffer_load_dwordx2 v[210:211], v224, s[52:55], 0 offen offset:2048 nt
    buffer_load_dwordx2 v[212:213], v224, s[52:55], s68 offen nt
    buffer_load_dwordx2 v[214:215], v224, s[52:55], s68 offen offset:2048 nt
    buffer_load_dwordx2 v[216:217], v224, s[52:55], s69 offen nt
    buffer_load_dwordx2 v[218:219], v224, s[52:55], s69 offen offset:2048 nt
    buffer_load_dwordx2 v[220:221], v224, s[52:55], s70 offen nt
    buffer_load_dwordx2 v[222:223], v224, s[52:55], s70 offen offset:2048 nt
    s_waitcnt lgkmcnt(0)
    v_and_b32 v172, s72, v53
    v_lshlrev_b32 v173, 16, v53
    v_and_b32 v174, s72, v52
    v_lshlrev_b32 v175, 16, v52
    v_fma_f32 v172, v172, s45, v20
    v_fma_f32 v173, v173, s45, v21
    v_fma_f32 v174, v174, s45, v22
    v_fma_f32 v175, v175, s45, v23
    v_cvt_pk_bf16_f32 v116, v172, v173
    v_cvt_pk_bf16_f32 v117, v174, v175
    v_and_b32 v172, s72, v55
    v_lshlrev_b32 v173, 16, v55
    v_and_b32 v174, s72, v54
    v_lshlrev_b32 v175, 16, v54
    v_fma_f32 v172, v172, s45, v24
    v_fma_f32 v173, v173, s45, v25
    v_fma_f32 v174, v174, s45, v26
    v_fma_f32 v175, v175, s45, v27
    v_cvt_pk_bf16_f32 v118, v172, v173
    v_cvt_pk_bf16_f32 v119, v174, v175
    s_nop 0
    v_permlane16_swap_b32 v116, v118
    v_permlane16_swap_b32 v117, v119
    v_and_b32 v172, s72, v57
    v_lshlrev_b32 v173, 16, v57
    v_and_b32 v174, s72, v56
    v_lshlrev_b32 v175, 16, v56
    v_fma_f32 v172, v172, s45, v28
    v_fma_f32 v173, v173, s45, v29
    v_fma_f32 v174, v174, s45, v30
    v_fma_f32 v175, v175, s45, v31
    v_cvt_pk_bf16_f32 v124, v172, v173
    v_cvt_pk_bf16_f32 v125, v174, v175
    v_and_b32 v172, s72, v59
    v_lshlrev_b32 v173, 16, v59
    v_and_b32 v174, s72, v58
    v_lshlrev_b32 v175, 16, v58
    v_fma_f32 v172, v172, s45, v32
    v_fma_f32 v173, v173, s45, v33
    v_fma_f32 v174, v174, s45, v34
    v_fma_f32 v175, v175, s45, v35
    v_cvt_pk_bf16_f32 v126, v172, v173
    v_cvt_pk_bf16_f32 v127, v174, v175
    s_nop 0
    v_permlane16_swap_b32 v124, v126
    v_permlane16_swap_b32 v125, v127
    v_and_b32 v172, s72, v61
    v_lshlrev_b32 v173, 16, v61
    v_and_b32 v174, s72, v60
    v_lshlrev_b32 v175, 16, v60
    v_fma_f32 v172, v172, s45, v36
    v_fma_f32 v173, v173, s45, v37
    v_fma_f32 v174, v174, s45, v38
    v_fma_f32 v175, v175, s45, v39
    v_cvt_pk_bf16_f32 v132, v172, v173
    v_cvt_pk_bf16_f32 v133, v174, v175
    v_and_b32 v172, s72, v63
    v_lshlrev_b32 v173, 16, v63
    v_and_b32 v174, s72, v62
    v_lshlrev_b32 v175, 16, v62
    v_fma_f32 v172, v172, s45, v40
    v_fma_f32 v173, v173, s45, v41
    v_fma_f32 v174, v174, s45, v42
    v_fma_f32 v175, v175, s45, v43
    v_cvt_pk_bf16_f32 v134, v172, v173
    v_cvt_pk_bf16_f32 v135, v174, v175
    s_nop 0
    v_permlane16_swap_b32 v132, v134
    v_permlane16_swap_b32 v133, v135
    v_and_b32 v172, s72, v65
    v_lshlrev_b32 v173, 16, v65
    v_and_b32 v174, s72, v64
    v_lshlrev_b32 v175, 16, v64
    v_fma_f32 v172, v172, s45, v44
    v_fma_f32 v173, v173, s45, v45
    v_fma_f32 v174, v174, s45, v46
    v_fma_f32 v175, v175, s45, v47
    v_cvt_pk_bf16_f32 v140, v172, v173
    v_cvt_pk_bf16_f32 v141, v174, v175
    v_and_b32 v172, s72, v67
    v_lshlrev_b32 v173, 16, v67
    v_and_b32 v174, s72, v66
    v_lshlrev_b32 v175, 16, v66
    v_fma_f32 v172, v172, s45, v48
    v_fma_f32 v173, v173, s45, v49
    v_fma_f32 v174, v174, s45, v50
    v_fma_f32 v175, v175, s45, v51
    v_cvt_pk_bf16_f32 v142, v172, v173
    v_cvt_pk_bf16_f32 v143, v174, v175
    s_nop 0
    v_permlane16_swap_b32 v140, v142
    v_permlane16_swap_b32 v141, v143
    s_cmp_eq_u32 s79, 0
    s_cbranch_scc1 L_stg_36
    buffer_store_dwordx4 v[116:119], v241, s[84:87], s36 offen
    buffer_store_dwordx4 v[124:127], v241, s[84:87], s37 offen
    buffer_store_dwordx4 v[132:135], v241, s[84:87], s38 offen
    buffer_store_dwordx4 v[140:143], v241, s[84:87], s39 offen
    s_branch L_stl_37
L_stg_36:
    buffer_store_dwordx4 v[116:119], v241, s[84:87], s36 offen sc1
    buffer_store_dwordx4 v[124:127], v241, s[84:87], s37 offen sc1
    buffer_store_dwordx4 v[132:135], v241, s[84:87], s38 offen sc1
    buffer_store_dwordx4 v[140:143], v241, s[84:87], s39 offen sc1
L_stl_37:
    s_waitcnt vmcnt(0)
    s_barrier
    s_cmp_lg_u32 s3, 0
    s_cbranch_scc1 L_sig_38
    v_mov_b32 v12, s47
    v_mov_b32 v13, s101
    s_mov_b64 exec, 1
    s_cmp_eq_u32 s79, 0
    s_cbranch_scc1 L_stg_39
    buffer_store_dword v13, v12, s[28:31], 0 offen
    s_branch L_stl_40
L_stg_39:
    buffer_store_dword v13, v12, s[28:31], 0 offen sc1
L_stl_40:
    s_mov_b64 exec, -1
L_sig_38:
    s_mov_b32 s50, 0xffff0000
    s_lshl_b32 s51, s89, 10
    s_add_u32 s51, s51, 53248
    v_and_b32 v12, 15, v1
    v_lshlrev_b32 v12, 6, v12
    v_add_u32 v12, s51, v12
    s_waitcnt vmcnt(0)
    v_lshlrev_b32 v80, 16, v208
    v_and_b32 v81, s50, v208
    v_lshlrev_b32 v82, 16, v209
    v_and_b32 v83, s50, v209
    v_lshlrev_b32 v84, 16, v210
    v_and_b32 v85, s50, v210
    v_lshlrev_b32 v86, 16, v211
    v_and_b32 v87, s50, v211
    v_lshlrev_b32 v88, 16, v212
    v_and_b32 v89, s50, v212
    v_lshlrev_b32 v90, 16, v213
    v_and_b32 v91, s50, v213
    v_lshlrev_b32 v92, 16, v214
    v_and_b32 v93, s50, v214
    v_lshlrev_b32 v94, 16, v215
    v_and_b32 v95, s50, v215
    v_lshlrev_b32 v96, 16, v216
    v_and_b32 v97, s50, v216
    v_lshlrev_b32 v98, 16, v217
    v_and_b32 v99, s50, v217
    v_lshlrev_b32 v100, 16, v218
    v_and_b32 v101, s50, v218
    v_lshlrev_b32 v102, 16, v219
    v_and_b32 v103, s50, v219
    v_lshlrev_b32 v104, 16, v220
    v_and_b32 v105, s50, v220
    v_lshlrev_b32 v106, 16, v221
    v_and_b32 v107, s50, v221
    v_lshlrev_b32 v108, 16, v222
    v_and_b32 v109, s50, v222
    v_lshlrev_b32 v110, 16, v223
    v_and_b32 v111, s50, v223
    s_cmp_lg_u32 s3, 0
    s_cbranch_scc1 L_pdone_42
    s_mov_b32 s51, 0
L_poll_41:
    buffer_load_dword v13, v12, s[28:31], 0 offen sc1
    s_add_u32 s51, s51, 1
    s_waitcnt vmcnt(0)
    v_xor_b32 v13, s101, v13
    v_cmp_ne_u32 vcc, 0, v13
    s_cbranch_vccz L_prest_43
    s_cmp_lt_u32 s51, 400000
    s_cbranch_scc1 L_poll_41
L_prest_43:
L_pdone_42:
    s_barrier
    buffer_load_dwordx4 v[16:19], v225, s[60:63], 0 offen nt
    buffer_load_dwordx4 v[20:23], v225, s[60:63], s32 offen nt
    buffer_load_dwordx4 v[24:27], v225, s[60:63], s33 offen nt
    buffer_load_dwordx4 v[28:31], v225, s[60:63], s34 offen nt
    s_waitcnt vmcnt(3)
    v_lshlrev_b32 v48, 16, v16
    v_and_b32 v52, s50, v16
    v_lshlrev_b32 v56, 16, v17
    v_and_b32 v60, s50, v17
    v_lshlrev_b32 v64, 16, v18
    v_and_b32 v68, s50, v18
    v_lshlrev_b32 v72, 16, v19
    v_and_b32 v76, s50, v19
    s_waitcnt vmcnt(2)
    v_lshlrev_b32 v49, 16, v20
    v_and_b32 v53, s50, v20
    v_lshlrev_b32 v57, 16, v21
    v_and_b32 v61, s50, v21
    v_lshlrev_b32 v65, 16, v22
    v_and_b32 v69, s50, v22
    v_lshlrev_b32 v73, 16, v23
    v_and_b32 v77, s50, v23
    s_waitcnt vmcnt(1)
    v_lshlrev_b32 v50, 16, v24
    v_and_b32 v54, s50, v24
    v_lshlrev_b32 v58, 16, v25
    v_and_b32 v62, s50, v25
    v_lshlrev_b32 v66, 16, v26
    v_and_b32 v70, s50, v26
    v_lshlrev_b32 v74, 16, v27
    v_and_b32 v78, s50, v27
    s_waitcnt vmcnt(0)
    v_lshlrev_b32 v51, 16, v28
    v_and_b32 v55, s50, v28
    v_lshlrev_b32 v59, 16, v29
    v_and_b32 v63, s50, v29
    v_lshlrev_b32 v67, 16, v30
    v_and_b32 v71, s50, v30
    v_lshlrev_b32 v75, 16, v31
    v_and_b32 v79, s50, v31
    s_barrier
    v_pk_mul_f32 v[80:81], v[80:81], v[48:49]
    v_pk_mul_f32 v[82:83], v[82:83], v[50:51]
    v_cvt_pk_bf16_f32 v112, v80, v81
    v_cvt_pk_bf16_f32 v113, v82, v83
    buffer_store_dwordx2 v[112:113], v226, s[60:63], 0 offen nt
    v_pk_mul_f32 v[84:85], v[84:85], v[52:53]
    v_pk_mul_f32 v[86:87], v[86:87], v[54:55]
    v_cvt_pk_bf16_f32 v114, v84, v85
    v_cvt_pk_bf16_f32 v115, v86, v87
    buffer_store_dwordx2 v[114:115], v226, s[60:63], s68 offen nt
    v_pk_mul_f32 v[88:89], v[88:89], v[56:57]
    v_pk_mul_f32 v[90:91], v[90:91], v[58:59]
    v_cvt_pk_bf16_f32 v116, v88, v89
    v_cvt_pk_bf16_f32 v117, v90, v91
    buffer_store_dwordx2 v[116:117], v226, s[60:63], s69 offen nt
    v_pk_mul_f32 v[92:93], v[92:93], v[60:61]
    v_pk_mul_f32 v[94:95], v[94:95], v[62:63]
    v_cvt_pk_bf16_f32 v118, v92, v93
    v_cvt_pk_bf16_f32 v119, v94, v95
    buffer_store_dwordx2 v[118:119], v226, s[60:63], s70 offen nt
    v_pk_mul_f32 v[96:97], v[96:97], v[64:65]
    v_pk_mul_f32 v[98:99], v[98:99], v[66:67]
    v_cvt_pk_bf16_f32 v120, v96, v97
    v_cvt_pk_bf16_f32 v121, v98, v99
    buffer_store_dwordx2 v[120:121], v226, s[60:63], s71 offen nt
    v_pk_mul_f32 v[100:101], v[100:101], v[68:69]
    v_pk_mul_f32 v[102:103], v[102:103], v[70:71]
    v_cvt_pk_bf16_f32 v122, v100, v101
    v_cvt_pk_bf16_f32 v123, v102, v103
    buffer_store_dwordx2 v[122:123], v226, s[60:63], s76 offen nt
    v_pk_mul_f32 v[104:105], v[104:105], v[72:73]
    v_pk_mul_f32 v[106:107], v[106:107], v[74:75]
    v_cvt_pk_bf16_f32 v124, v104, v105
    v_cvt_pk_bf16_f32 v125, v106, v107
    buffer_store_dwordx2 v[124:125], v226, s[60:63], s77 offen nt
    v_pk_mul_f32 v[108:109], v[108:109], v[76:77]
    v_pk_mul_f32 v[110:111], v[110:111], v[78:79]
    v_cvt_pk_bf16_f32 v126, v108, v109
    v_cvt_pk_bf16_f32 v127, v110, v111
    buffer_store_dwordx2 v[126:127], v226, s[60:63], s78 offen nt
    s_branch L_fin
L_A:
    s_setprio 2
    s_mov_b32 s40, s91
    s_setprio 0
    s_mov_b32 s32, s4
    s_mov_b32 s33, s5
    s_mov_b32 s34, 4194304
    s_mov_b32 s35, 0x00020000
    s_lshr_b32 s48, s91, 3
    s_and_b32 s49, s91, 7
    s_lshr_b32 s41, s48, 2
    s_bfe_u32 s50, s48, 0x10001
    s_lshl_b32 s50, s50, 3
    s_add_u32 s50, s50, s49
    s_lshl_b32 s50, s50, 1
    s_and_b32 s51, s48, 1
    s_add_u32 s42, s50, s51
    v_and_b32 v2, 15, v1
    v_lshrrev_b32 v3, 4, v1
    v_lshlrev_b32 v4, 20, v3
    v_lshl_add_u32 v4, v2, 2, v4
    s_lshl_b32 s48, s41, 11
    s_lshl_b32 s49, s42, 6
    s_add_u32 s48, s48, s49
    s_lshl_b32 s50, s3, 16
    s_add_u32 s50, s50, s48
    s_add_u32 s52, s50, 0
    buffer_load_dword v16, v4, s[32:35], s52 offen  nt
    s_add_u32 s53, s50, 262144
    buffer_load_dword v17, v4, s[32:35], s53 offen  nt
    s_add_u32 s54, s50, 524288
    buffer_load_dword v18, v4, s[32:35], s54 offen  nt
    s_add_u32 s55, s50, 786432
    buffer_load_dword v19, v4, s[32:35], s55 offen  nt
    s_add_u32 s56, s50, 16384
    buffer_load_dword v20, v4, s[32:35], s56 offen  nt
    s_add_u32 s57, s50, 278528
    buffer_load_dword v21, v4, s[32:35], s57 offen  nt
    s_add_u32 s58, s50, 540672
    buffer_load_dword v22, v4, s[32:35], s58 offen  nt
    s_add_u32 s59, s50, 802816
    buffer_load_dword v23, v4, s[32:35], s59 offen  nt
    s_add_u32 s60, s50, 32768
    buffer_load_dword v24, v4, s[32:35], s60 offen  nt
    s_add_u32 s61, s50, 294912
    buffer_load_dword v25, v4, s[32:35], s61 offen  nt
    s_add_u32 s62, s50, 557056
    buffer_load_dword v26, v4, s[32:35], s62 offen  nt
    s_add_u32 s63, s50, 819200
    buffer_load_dword v27, v4, s[32:35], s63 offen  nt
    s_add_u32 s64, s50, 49152
    buffer_load_dword v28, v4, s[32:35], s64 offen  nt
    s_add_u32 s65, s50, 311296
    buffer_load_dword v29, v4, s[32:35], s65 offen  nt
    s_add_u32 s66, s50, 573440
    buffer_load_dword v30, v4, s[32:35], s66 offen  nt
    s_add_u32 s67, s50, 835584
    buffer_load_dword v31, v4, s[32:35], s67 offen  nt
    v_lshlrev_b32 v6, 18, v2
    v_lshl_add_u32 v6, v3, 4, v6
    s_lshl_b32 s50, s3, 16
    s_add_u32 s50, s50, s48
    s_add_u32 s68, s50, 0
    s_add_u32 s69, s50, 16384
    s_add_u32 s70, s50, 32768
    s_add_u32 s71, s50, 49152
    v_bfe_u32 v11, v2, 1, 2
    v_xor_b32 v12, s3, v11
    v_lshlrev_b32 v7, 4, v12
    v_lshl_add_u32 v7, v2, 6, v7
    v_lshl_add_u32 v7, v3, 12, v7
    v_xor_b32 v12, v3, v11
    v_lshlrev_b32 v8, 4, v12
    v_lshl_add_u32 v8, v2, 6, v8
    s_lshl_b32 s50, s3, 12
    v_add_u32 v8, s50, v8
    v_cvt_f32_u32 v11, v2
    v_mul_f32 v11, 0x3d800000, v11
    v_cvt_f32_u32 v13, v3
    v_mul_f32 v13, 4.0, v13
    v_mul_f32 v12, v13, v11
    v_mov_b32 v168, v12
    v_cos_f32 v169, v168
    v_sin_f32 v170, v168
    s_nop 0
    v_cvt_pk_bf16_f32 v48, v169, v170
    v_cvt_pk_bf16_f32 v52, -v170, v169
    v_fmamk_f32 v171, v11, 0x3f800000, v12
    v_cos_f32 v172, v171
    v_sin_f32 v173, v171
    s_nop 0
    v_cvt_pk_bf16_f32 v49, v172, v173
    v_cvt_pk_bf16_f32 v53, -v173, v172
    v_fmamk_f32 v168, v11, 0x40000000, v12
    v_cos_f32 v169, v168
    v_sin_f32 v170, v168
    s_nop 0
    v_cvt_pk_bf16_f32 v50, v169, v170
    v_cvt_pk_bf16_f32 v54, -v170, v169
    v_fmamk_f32 v171, v11, 0x40400000, v12
    v_cos_f32 v172, v171
    v_sin_f32 v173, v171
    s_nop 0
    v_cvt_pk_bf16_f32 v51, v172, v173
    v_cvt_pk_bf16_f32 v55, -v173, v172
    v_cvt_f32_u32 v168, s3
    v_mul_f32 v168, 0x3c800000, v168
    v_add_f32 v172, 0, v13
    v_add_f32 v173, 0x3f800000, v13
    v_add_f32 v174, 0x40000000, v13
    v_add_f32 v175, 0x40400000, v13
    v_add_f32 v169, 0, v168
    v_mul_f32 v14, v169, v172
    v_cos_f32 v56, v14
    v_sin_f32 v88, v14
    v_mul_f32 v15, v169, v173
    v_cos_f32 v57, v15
    v_sin_f32 v89, v15
    v_mul_f32 v14, v169, v174
    v_cos_f32 v58, v14
    v_sin_f32 v90, v14
    v_mul_f32 v15, v169, v175
    v_cos_f32 v59, v15
    v_sin_f32 v91, v15
    v_add_f32 v169, 0x3b800000, v168
    v_mul_f32 v14, v169, v172
    v_cos_f32 v60, v14
    v_sin_f32 v92, v14
    v_mul_f32 v15, v169, v173
    v_cos_f32 v61, v15
    v_sin_f32 v93, v15
    v_mul_f32 v14, v169, v174
    v_cos_f32 v62, v14
    v_sin_f32 v94, v14
    v_mul_f32 v15, v169, v175
    v_cos_f32 v63, v15
    v_sin_f32 v95, v15
    v_add_f32 v169, 0x3c000000, v168
    v_mul_f32 v14, v169, v172
    v_cos_f32 v64, v14
    v_sin_f32 v96, v14
    v_mul_f32 v15, v169, v173
    v_cos_f32 v65, v15
    v_sin_f32 v97, v15
    v_mul_f32 v14, v169, v174
    v_cos_f32 v66, v14
    v_sin_f32 v98, v14
    v_mul_f32 v15, v169, v175
    v_cos_f32 v67, v15
    v_sin_f32 v99, v15
    v_add_f32 v169, 0x3c400000, v168
    v_mul_f32 v14, v169, v172
    v_cos_f32 v68, v14
    v_sin_f32 v100, v14
    v_mul_f32 v15, v169, v173
    v_cos_f32 v69, v15
    v_sin_f32 v101, v15
    v_mul_f32 v14, v169, v174
    v_cos_f32 v70, v14
    v_sin_f32 v102, v14
    v_mul_f32 v15, v169, v175
    v_cos_f32 v71, v15
    v_sin_f32 v103, v15
    s_mov_b32 s36, s26
    s_mov_b32 s37, s27
    s_mov_b32 s38, 4194304
    s_mov_b32 s39, 0x00020000
    s_mov_b32 s80, s6
    s_mov_b32 s81, s7
    s_mov_b32 s82, 2101248
    s_mov_b32 s83, 0x00020000
    s_mov_b32 s84, s8
    s_mov_b32 s85, s9
    s_mov_b32 s86, 2101248
    s_mov_b32 s87, 0x00020000
    s_lshl_b32 s47, s3, 9
    s_add_u32 s43, s40, s47
    s_mov_b32 s73, s40
    s_sub_u32 s74, 512, s40
    s_cmp_lg_u32 s40, 0
    s_cbranch_scc1 L_reg_45
    s_mov_b32 s74, 256
    s_lshl_b32 s47, s3, 2
    s_lshr_b32 s46, 0x3120, s47
    s_and_b32 s46, s46, 15
    s_lshl_b32 s43, s46, 8
L_reg_45:
    s_sub_u32 s72, 2048, s43
    s_and_b32 s72, s72, 2047
    s_mul_i32 s43, s43, 1026
    s_mul_i32 s72, s72, 1026
    s_or_b32 s75, s40, s3
    s_cmp_lg_u32 s75, 0
    s_cbranch_scc1 L_now2_46
    v_lshlrev_b32 v243, 4, v1
    s_mov_b32 s47, 1050624
    s_mov_b32 s46, 49152
    s_mov_b32 m0, s46
    s_nop 0
    buffer_load_dwordx4 v243, s[80:83], s47 offen nt lds
    s_add_u32 s93, s46, 1024
    s_mov_b32 m0, s93
    s_nop 0
    buffer_load_dwordx4 v243, s[84:87], s47 offen nt lds
    s_add_u32 s92, s47, 2
    s_add_u32 s93, s46, 2048
    s_mov_b32 m0, s93
    s_nop 0
    buffer_load_dwordx4 v243, s[80:83], s92 offen nt lds
    s_add_u32 s93, s46, 3072
    s_mov_b32 m0, s93
    s_nop 0
    buffer_load_dwordx4 v243, s[84:87], s92 offen nt lds
    v_mov_b32 v244, s47
    v_mov_b32 v245, s47
    v_add_u32 v245, 1024, v245
    buffer_load_short_d16_hi v252, v244, s[80:83], 0 offen
    buffer_load_short_d16_hi v253, v244, s[84:87], 0 offen
    buffer_load_short_d16_hi v254, v245, s[80:83], 0 offen
    buffer_load_short_d16_hi v255, v245, s[84:87], 0 offen
L_now2_46:
    s_waitcnt vmcnt(12)
    v_mfma_f32_16x16x32_bf16 v[120:123], v[48:51], v[16:19], 0
    v_mfma_f32_16x16x32_bf16 v[136:139], v[52:55], v[16:19], 0
    s_waitcnt vmcnt(8)
    v_mfma_f32_16x16x32_bf16 v[124:127], v[48:51], v[20:23], 0
    v_mfma_f32_16x16x32_bf16 v[140:143], v[52:55], v[20:23], 0
    s_waitcnt vmcnt(4)
    v_mfma_f32_16x16x32_bf16 v[128:131], v[48:51], v[24:27], 0
    v_mfma_f32_16x16x32_bf16 v[144:147], v[52:55], v[24:27], 0
    s_waitcnt vmcnt(0)
    v_mfma_f32_16x16x32_bf16 v[132:135], v[48:51], v[28:31], 0
    v_mfma_f32_16x16x32_bf16 v[148:151], v[52:55], v[28:31], 0
    v_pk_mul_f32 v[168:169], v[120:121], v[56:57]
    v_pk_mul_f32 v[170:171], v[136:137], v[56:57]
    v_pk_fma_f32 v[168:169], v[136:137], v[88:89], v[168:169]
    v_pk_fma_f32 v[170:171], v[120:121], v[88:89], v[170:171] neg_lo:[1,0,0] neg_hi:[1,0,0]
    v_cvt_pk_bf16_f32 v152, v168, v170
    v_cvt_pk_bf16_f32 v156, v169, v171
    v_pk_mul_f32 v[172:173], v[122:123], v[58:59]
    v_pk_mul_f32 v[174:175], v[138:139], v[58:59]
    v_pk_fma_f32 v[172:173], v[138:139], v[90:91], v[172:173]
    v_pk_fma_f32 v[174:175], v[122:123], v[90:91], v[174:175] neg_lo:[1,0,0] neg_hi:[1,0,0]
    v_cvt_pk_bf16_f32 v160, v172, v174
    v_cvt_pk_bf16_f32 v164, v173, v175
    v_pk_mul_f32 v[168:169], v[124:125], v[60:61]
    v_pk_mul_f32 v[170:171], v[140:141], v[60:61]
    v_pk_fma_f32 v[168:169], v[140:141], v[92:93], v[168:169]
    v_pk_fma_f32 v[170:171], v[124:125], v[92:93], v[170:171] neg_lo:[1,0,0] neg_hi:[1,0,0]
    v_cvt_pk_bf16_f32 v153, v168, v170
    v_cvt_pk_bf16_f32 v157, v169, v171
    v_pk_mul_f32 v[172:173], v[126:127], v[62:63]
    v_pk_mul_f32 v[174:175], v[142:143], v[62:63]
    v_pk_fma_f32 v[172:173], v[142:143], v[94:95], v[172:173]
    v_pk_fma_f32 v[174:175], v[126:127], v[94:95], v[174:175] neg_lo:[1,0,0] neg_hi:[1,0,0]
    v_cvt_pk_bf16_f32 v161, v172, v174
    v_cvt_pk_bf16_f32 v165, v173, v175
    v_pk_mul_f32 v[168:169], v[128:129], v[64:65]
    v_pk_mul_f32 v[170:171], v[144:145], v[64:65]
    v_pk_fma_f32 v[168:169], v[144:145], v[96:97], v[168:169]
    v_pk_fma_f32 v[170:171], v[128:129], v[96:97], v[170:171] neg_lo:[1,0,0] neg_hi:[1,0,0]
    v_cvt_pk_bf16_f32 v154, v168, v170
    v_cvt_pk_bf16_f32 v158, v169, v171
    v_pk_mul_f32 v[172:173], v[130:131], v[66:67]
    v_pk_mul_f32 v[174:175], v[146:147], v[66:67]
    v_pk_fma_f32 v[172:173], v[146:147], v[98:99], v[172:173]
    v_pk_fma_f32 v[174:175], v[130:131], v[98:99], v[174:175] neg_lo:[1,0,0] neg_hi:[1,0,0]
    v_cvt_pk_bf16_f32 v162, v172, v174
    v_cvt_pk_bf16_f32 v166, v173, v175
    v_pk_mul_f32 v[168:169], v[132:133], v[68:69]
    v_pk_mul_f32 v[170:171], v[148:149], v[68:69]
    v_pk_fma_f32 v[168:169], v[148:149], v[100:101], v[168:169]
    v_pk_fma_f32 v[170:171], v[132:133], v[100:101], v[170:171] neg_lo:[1,0,0] neg_hi:[1,0,0]
    v_cvt_pk_bf16_f32 v155, v168, v170
    v_cvt_pk_bf16_f32 v159, v169, v171
    v_pk_mul_f32 v[172:173], v[134:135], v[70:71]
    v_pk_mul_f32 v[174:175], v[150:151], v[70:71]
    v_pk_fma_f32 v[172:173], v[150:151], v[102:103], v[172:173]
    v_pk_fma_f32 v[174:175], v[134:135], v[102:103], v[174:175] neg_lo:[1,0,0] neg_hi:[1,0,0]
    v_cvt_pk_bf16_f32 v163, v172, v174
    v_cvt_pk_bf16_f32 v167, v173, v175
    ds_write_b128 v7, v[152:155] offset:0
    ds_write_b128 v7, v[156:159] offset:1024
    ds_write_b128 v7, v[160:163] offset:2048
    ds_write_b128 v7, v[164:167] offset:3072
    s_waitcnt lgkmcnt(0)
    s_barrier
    ds_read_b128 v[16:19], v8 offset:0
    ds_read_b128 v[20:23], v8 offset:1024
    ds_read_b128 v[24:27], v8 offset:2048
    ds_read_b128 v[28:31], v8 offset:3072
    s_waitcnt lgkmcnt(3)
    v_mfma_f32_16x16x32_bf16 v[120:123], v[16:19], v[48:51], 0
    v_mfma_f32_16x16x32_bf16 v[136:139], v[16:19], v[52:55], 0
    s_waitcnt lgkmcnt(2)
    v_mfma_f32_16x16x32_bf16 v[124:127], v[20:23], v[48:51], 0
    v_mfma_f32_16x16x32_bf16 v[140:143], v[20:23], v[52:55], 0
    s_waitcnt lgkmcnt(1)
    v_mfma_f32_16x16x32_bf16 v[128:131], v[24:27], v[48:51], 0
    v_mfma_f32_16x16x32_bf16 v[144:147], v[24:27], v[52:55], 0
    s_waitcnt lgkmcnt(0)
    v_mfma_f32_16x16x32_bf16 v[132:135], v[28:31], v[48:51], 0
    v_mfma_f32_16x16x32_bf16 v[148:151], v[28:31], v[52:55], 0
    v_cvt_pk_bf16_f32 v152, v120, v136
    v_cvt_pk_bf16_f32 v153, v121, v137
    v_cvt_pk_bf16_f32 v154, v122, v138
    v_cvt_pk_bf16_f32 v155, v123, v139
    buffer_store_dwordx4 v[152:155], v6, s[36:39], s68 offen sc1
    v_cvt_pk_bf16_f32 v156, v124, v140
    v_cvt_pk_bf16_f32 v157, v125, v141
    v_cvt_pk_bf16_f32 v158, v126, v142
    v_cvt_pk_bf16_f32 v159, v127, v143
    buffer_store_dwordx4 v[156:159], v6, s[36:39], s69 offen sc1
    v_cvt_pk_bf16_f32 v160, v128, v144
    v_cvt_pk_bf16_f32 v161, v129, v145
    v_cvt_pk_bf16_f32 v162, v130, v146
    v_cvt_pk_bf16_f32 v163, v131, v147
    buffer_store_dwordx4 v[160:163], v6, s[36:39], s70 offen sc1
    v_cvt_pk_bf16_f32 v164, v132, v148
    v_cvt_pk_bf16_f32 v165, v133, v149
    v_cvt_pk_bf16_f32 v166, v134, v150
    v_cvt_pk_bf16_f32 v167, v135, v151
    buffer_store_dwordx4 v[164:167], v6, s[36:39], s71 offen sc1
    s_nop 1
    v_and_b32 v2, 31, v1
    v_lshrrev_b32 v3, 5, v1
    v_cvt_f32_u32 v190, v2
    v_cvt_f32_u32 v191, v3
    v_mul_f32 v191, 4.0, v191
    v_mul_f32 v188, 0x3d000000, v190
    v_mul_f32 v189, v191, v188
    v_and_b32 v192, 1, v2
    v_mul_u32_u24 v192, 0x8000, v192
    v_lshl_or_b32 v192, v192, 16, v192
    v_mov_b32 v193, v189
    v_cos_f32 v194, v193
    v_sin_f32 v195, v193
    s_nop 0
    v_cvt_pk_bf16_f32 v16, v194, v195
    v_cvt_pk_bf16_f32 v32, -v195, v194
    v_fmamk_f32 v196, v188, 0x3f800000, v189
    v_cos_f32 v197, v196
    v_sin_f32 v198, v196
    s_nop 0
    v_cvt_pk_bf16_f32 v17, v197, v198
    v_cvt_pk_bf16_f32 v33, -v198, v197
    v_fmamk_f32 v193, v188, 0x40000000, v189
    v_cos_f32 v194, v193
    v_sin_f32 v195, v193
    s_nop 0
    v_cvt_pk_bf16_f32 v18, v194, v195
    v_cvt_pk_bf16_f32 v34, -v195, v194
    v_fmamk_f32 v196, v188, 0x40400000, v189
    v_cos_f32 v197, v196
    v_sin_f32 v198, v196
    s_nop 0
    v_cvt_pk_bf16_f32 v19, v197, v198
    v_cvt_pk_bf16_f32 v35, -v198, v197
    v_fmamk_f32 v193, v188, 0x41000000, v189
    v_cos_f32 v194, v193
    v_sin_f32 v195, v193
    s_nop 0
    v_cvt_pk_bf16_f32 v20, v194, v195
    v_cvt_pk_bf16_f32 v36, -v195, v194
    v_fmamk_f32 v196, v188, 0x41100000, v189
    v_cos_f32 v197, v196
    v_sin_f32 v198, v196
    s_nop 0
    v_cvt_pk_bf16_f32 v21, v197, v198
    v_cvt_pk_bf16_f32 v37, -v198, v197
    v_fmamk_f32 v193, v188, 0x41200000, v189
    v_cos_f32 v194, v193
    v_sin_f32 v195, v193
    s_nop 0
    v_cvt_pk_bf16_f32 v22, v194, v195
    v_cvt_pk_bf16_f32 v38, -v195, v194
    v_fmamk_f32 v196, v188, 0x41300000, v189
    v_cos_f32 v197, v196
    v_sin_f32 v198, v196
    s_nop 0
    v_cvt_pk_bf16_f32 v23, v197, v198
    v_cvt_pk_bf16_f32 v39, -v198, v197
    v_xor_b32 v24, v192, v16
    v_xor_b32 v25, v192, v17
    v_xor_b32 v26, v192, v18
    v_xor_b32 v27, v192, v19
    v_xor_b32 v28, v192, v20
    v_xor_b32 v29, v192, v21
    v_xor_b32 v30, v192, v22
    v_xor_b32 v31, v192, v23
    v_xor_b32 v40, v192, v32
    v_xor_b32 v41, v192, v33
    v_xor_b32 v42, v192, v34
    v_xor_b32 v43, v192, v35
    v_xor_b32 v44, v192, v36
    v_xor_b32 v45, v192, v37
    v_xor_b32 v46, v192, v38
    v_xor_b32 v47, v192, v39
    v_mul_f32 v188, 0x3a800000, v190
    v_mul_f32 v189, v191, v188
    v_mov_b32 v193, v189
    v_cos_f32 v48, v193
    v_sin_f32 v64, v193
    v_fmamk_f32 v194, v188, 0x3f800000, v189
    v_cos_f32 v49, v194
    v_sin_f32 v65, v194
    v_fmamk_f32 v193, v188, 0x40000000, v189
    v_cos_f32 v50, v193
    v_sin_f32 v66, v193
    v_fmamk_f32 v194, v188, 0x40400000, v189
    v_cos_f32 v51, v194
    v_sin_f32 v67, v194
    v_fmamk_f32 v193, v188, 0x41000000, v189
    v_cos_f32 v52, v193
    v_sin_f32 v68, v193
    v_fmamk_f32 v194, v188, 0x41100000, v189
    v_cos_f32 v53, v194
    v_sin_f32 v69, v194
    v_fmamk_f32 v193, v188, 0x41200000, v189
    v_cos_f32 v54, v193
    v_sin_f32 v70, v193
    v_fmamk_f32 v194, v188, 0x41300000, v189
    v_cos_f32 v55, v194
    v_sin_f32 v71, v194
    v_fmamk_f32 v193, v188, 0x41800000, v189
    v_cos_f32 v56, v193
    v_sin_f32 v72, v193
    v_fmamk_f32 v194, v188, 0x41880000, v189
    v_cos_f32 v57, v194
    v_sin_f32 v73, v194
    v_fmamk_f32 v193, v188, 0x41900000, v189
    v_cos_f32 v58, v193
    v_sin_f32 v74, v193
    v_fmamk_f32 v194, v188, 0x41980000, v189
    v_cos_f32 v59, v194
    v_sin_f32 v75, v194
    v_fmamk_f32 v193, v188, 0x41c00000, v189
    v_cos_f32 v60, v193
    v_sin_f32 v76, v193
    v_fmamk_f32 v194, v188, 0x41c80000, v189
    v_cos_f32 v61, v194
    v_sin_f32 v77, v194
    v_fmamk_f32 v193, v188, 0x41d00000, v189
    v_cos_f32 v62, v193
    v_sin_f32 v78, v193
    v_fmamk_f32 v194, v188, 0x41d80000, v189
    v_cos_f32 v63, v194
    v_sin_f32 v79, v194
    v_and_b32 v188, 3, v2
    v_bfe_u32 v189, v2, 2, 2
    v_and_b32 v201, 15, v1
    v_lshrrev_b32 v202, 4, v1
    s_cmp_eq_u32 s40, 0
    s_cbranch_scc1 L_ghspec_47
    v_cvt_f32_u32 v198, s40
    v_cvt_f32_u32 v196, v189
    v_fmamk_f32 v196, v196, 0x44000000, v198
    v_mul_f32 v196, 0x3a000000, v196
    v_lshlrev_b32 v190, 3, v188
    s_mov_b32 s50, 0x4631914C
    v_lshrrev_b32 v190, v190, s50
    v_mov_b32 v191, 0.5
    v_cmp_gt_u32 vcc, 16, v2
    s_nop 1
    v_cndmask_b32 v191, 0, v191, vcc
    v_cvt_f32_u32 v192, v3
    v_add_f32 v192, v192, v192
    v_add_f32 v193, 1.0, v192
    v_mul_f32 v192, v192, v196
    v_mul_f32 v193, v193, v196
    v_bfe_u32 v194, v190, 0, 2
    v_cvt_f32_u32 v194, v194
    v_fmamk_f32 v194, v194, 0x3e800000, v192
    v_cos_f32 v194, v194
    s_nop 0
    v_mul_f32 v194, v194, v191
    v_bfe_u32 v195, v190, 2, 2
    v_cvt_f32_u32 v195, v195
    v_fmamk_f32 v195, v195, 0x3e800000, v192
    v_cos_f32 v195, v195
    s_nop 0
    v_mul_f32 v195, v195, v191
    v_cvt_pk_bf16_f32 v160, v194, v195
    v_bfe_u32 v194, v190, 4, 2
    v_cvt_f32_u32 v194, v194
    v_fmamk_f32 v194, v194, 0x3e800000, v192
    v_cos_f32 v194, v194
    s_nop 0
    v_mul_f32 v194, v194, v191
    v_bfe_u32 v195, v190, 6, 2
    v_cvt_f32_u32 v195, v195
    v_fmamk_f32 v195, v195, 0x3e800000, v192
    v_cos_f32 v195, v195
    s_nop 0
    v_mul_f32 v195, v195, v191
    v_cvt_pk_bf16_f32 v161, v194, v195
    v_bfe_u32 v194, v190, 0, 2
    v_cvt_f32_u32 v194, v194
    v_fmamk_f32 v194, v194, 0x3e800000, v193
    v_cos_f32 v194, v194
    s_nop 0
    v_mul_f32 v194, v194, v191
    v_bfe_u32 v195, v190, 2, 2
    v_cvt_f32_u32 v195, v195
    v_fmamk_f32 v195, v195, 0x3e800000, v193
    v_cos_f32 v195, v195
    s_nop 0
    v_mul_f32 v195, v195, v191
    v_cvt_pk_bf16_f32 v162, v194, v195
    v_bfe_u32 v194, v190, 4, 2
    v_cvt_f32_u32 v194, v194
    v_fmamk_f32 v194, v194, 0x3e800000, v193
    v_cos_f32 v194, v194
    s_nop 0
    v_mul_f32 v194, v194, v191
    v_bfe_u32 v195, v190, 6, 2
    v_cvt_f32_u32 v195, v195
    v_fmamk_f32 v195, v195, 0x3e800000, v193
    v_cos_f32 v195, v195
    s_nop 0
    v_mul_f32 v195, v195, v191
    v_cvt_pk_bf16_f32 v163, v194, v195
    v_cvt_f32_u32 v192, v3
    v_add_f32 v192, v192, v192
    v_add_f32 v192, 4.0, v192
    v_add_f32 v193, 1.0, v192
    v_mul_f32 v192, v192, v196
    v_mul_f32 v193, v193, v196
    v_bfe_u32 v194, v190, 0, 2
    v_cvt_f32_u32 v194, v194
    v_fmamk_f32 v194, v194, 0x3e800000, v192
    v_cos_f32 v194, v194
    s_nop 0
    v_mul_f32 v194, v194, v191
    v_bfe_u32 v195, v190, 2, 2
    v_cvt_f32_u32 v195, v195
    v_fmamk_f32 v195, v195, 0x3e800000, v192
    v_cos_f32 v195, v195
    s_nop 0
    v_mul_f32 v195, v195, v191
    v_cvt_pk_bf16_f32 v204, v194, v195
    v_bfe_u32 v194, v190, 4, 2
    v_cvt_f32_u32 v194, v194
    v_fmamk_f32 v194, v194, 0x3e800000, v192
    v_cos_f32 v194, v194
    s_nop 0
    v_mul_f32 v194, v194, v191
    v_bfe_u32 v195, v190, 6, 2
    v_cvt_f32_u32 v195, v195
    v_fmamk_f32 v195, v195, 0x3e800000, v192
    v_cos_f32 v195, v195
    s_nop 0
    v_mul_f32 v195, v195, v191
    v_cvt_pk_bf16_f32 v205, v194, v195
    v_bfe_u32 v194, v190, 0, 2
    v_cvt_f32_u32 v194, v194
    v_fmamk_f32 v194, v194, 0x3e800000, v193
    v_cos_f32 v194, v194
    s_nop 0
    v_mul_f32 v194, v194, v191
    v_bfe_u32 v195, v190, 2, 2
    v_cvt_f32_u32 v195, v195
    v_fmamk_f32 v195, v195, 0x3e800000, v193
    v_cos_f32 v195, v195
    s_nop 0
    v_mul_f32 v195, v195, v191
    v_cvt_pk_bf16_f32 v206, v194, v195
    v_bfe_u32 v194, v190, 4, 2
    v_cvt_f32_u32 v194, v194
    v_fmamk_f32 v194, v194, 0x3e800000, v193
    v_cos_f32 v194, v194
    s_nop 0
    v_mul_f32 v194, v194, v191
    v_bfe_u32 v195, v190, 6, 2
    v_cvt_f32_u32 v195, v195
    v_fmamk_f32 v195, v195, 0x3e800000, v193
    v_cos_f32 v195, v195
    s_nop 0
    v_mul_f32 v195, v195, v191
    v_cvt_pk_bf16_f32 v207, v194, v195
    v_bfe_u32 v189, v201, 1, 2
    v_cvt_f32_u32 v197, v189
    v_mul_f32 v197, 0x3a000000, v197
    v_and_b32 v196, 1, v202
    v_cvt_f32_u32 v196, v196
    v_fmamk_f32 v196, v196, 0x44800000, v198
    v_add_f32 v193, 0x44000000, v196
    v_mul_f32 v192, v196, v197
    v_mul_f32 v193, v193, v197
    v_lshrrev_b32 v203, 1, v202
    v_lshrrev_b32 v191, 3, v201
    v_cmp_eq_u32 vcc, v203, v191
    v_mov_b32 v191, 0x35000000
    s_nop 0
    v_cndmask_b32 v191, 0, v191, vcc
    v_and_b32 v199, 1, v201
    v_mov_b32 v190, 28
    v_mov_b32 v200, 188
    v_cmp_eq_u32 vcc, 1, v199
    s_nop 1
    v_cndmask_b32 v190, v190, v200, vcc
    v_bfe_u32 v194, v190, 0, 2
    v_cvt_f32_u32 v194, v194
    v_fmamk_f32 v194, v194, 0x3e800000, v192
    v_cos_f32 v194, v194
    s_nop 0
    v_mul_f32 v194, v194, v191
    v_bfe_u32 v195, v190, 2, 2
    v_cvt_f32_u32 v195, v195
    v_fmamk_f32 v195, v195, 0x3e800000, v192
    v_cos_f32 v195, v195
    s_nop 0
    v_mul_f32 v195, v195, v191
    v_cvt_pk_bf16_f32 v164, v194, v195
    v_bfe_u32 v194, v190, 4, 2
    v_cvt_f32_u32 v194, v194
    v_fmamk_f32 v194, v194, 0x3e800000, v192
    v_cos_f32 v194, v194
    s_nop 0
    v_mul_f32 v194, v194, v191
    v_bfe_u32 v195, v190, 6, 2
    v_cvt_f32_u32 v195, v195
    v_fmamk_f32 v195, v195, 0x3e800000, v192
    v_cos_f32 v195, v195
    s_nop 0
    v_mul_f32 v195, v195, v191
    v_cvt_pk_bf16_f32 v165, v194, v195
    v_bfe_u32 v194, v190, 0, 2
    v_cvt_f32_u32 v194, v194
    v_fmamk_f32 v194, v194, 0x3e800000, v193
    v_cos_f32 v194, v194
    s_nop 0
    v_mul_f32 v194, v194, v191
    v_bfe_u32 v195, v190, 2, 2
    v_cvt_f32_u32 v195, v195
    v_fmamk_f32 v195, v195, 0x3e800000, v193
    v_cos_f32 v195, v195
    s_nop 0
    v_mul_f32 v195, v195, v191
    v_cvt_pk_bf16_f32 v166, v194, v195
    v_bfe_u32 v194, v190, 4, 2
    v_cvt_f32_u32 v194, v194
    v_fmamk_f32 v194, v194, 0x3e800000, v193
    v_cos_f32 v194, v194
    s_nop 0
    v_mul_f32 v194, v194, v191
    v_bfe_u32 v195, v190, 6, 2
    v_cvt_f32_u32 v195, v195
    v_fmamk_f32 v195, v195, 0x3e800000, v193
    v_cos_f32 v195, v195
    s_nop 0
    v_mul_f32 v195, v195, v191
    v_cvt_pk_bf16_f32 v167, v194, v195
    v_mov_b32 v190, 97
    v_mov_b32 v200, 107
    v_cmp_eq_u32 vcc, 1, v199
    s_nop 1
    v_cndmask_b32 v190, v190, v200, vcc
    v_bfe_u32 v194, v190, 0, 2
    v_cvt_f32_u32 v194, v194
    v_fmamk_f32 v194, v194, 0x3e800000, v192
    v_cos_f32 v194, v194
    s_nop 0
    v_mul_f32 v194, v194, v191
    v_bfe_u32 v195, v190, 2, 2
    v_cvt_f32_u32 v195, v195
    v_fmamk_f32 v195, v195, 0x3e800000, v192
    v_cos_f32 v195, v195
    s_nop 0
    v_mul_f32 v195, v195, v191
    v_cvt_pk_bf16_f32 v168, v194, v195
    v_bfe_u32 v194, v190, 4, 2
    v_cvt_f32_u32 v194, v194
    v_fmamk_f32 v194, v194, 0x3e800000, v192
    v_cos_f32 v194, v194
    s_nop 0
    v_mul_f32 v194, v194, v191
    v_bfe_u32 v195, v190, 6, 2
    v_cvt_f32_u32 v195, v195
    v_fmamk_f32 v195, v195, 0x3e800000, v192
    v_cos_f32 v195, v195
    s_nop 0
    v_mul_f32 v195, v195, v191
    v_cvt_pk_bf16_f32 v169, v194, v195
    v_bfe_u32 v194, v190, 0, 2
    v_cvt_f32_u32 v194, v194
    v_fmamk_f32 v194, v194, 0x3e800000, v193
    v_cos_f32 v194, v194
    s_nop 0
    v_mul_f32 v194, v194, v191
    v_bfe_u32 v195, v190, 2, 2
    v_cvt_f32_u32 v195, v195
    v_fmamk_f32 v195, v195, 0x3e800000, v193
    v_cos_f32 v195, v195
    s_nop 0
    v_mul_f32 v195, v195, v191
    v_cvt_pk_bf16_f32 v170, v194, v195
    v_bfe_u32 v194, v190, 4, 2
    v_cvt_f32_u32 v194, v194
    v_fmamk_f32 v194, v194, 0x3e800000, v193
    v_cos_f32 v194, v194
    s_nop 0
    v_mul_f32 v194, v194, v191
    v_bfe_u32 v195, v190, 6, 2
    v_cvt_f32_u32 v195, v195
    v_fmamk_f32 v195, v195, 0x3e800000, v193
    v_cos_f32 v195, v195
    s_nop 0
    v_mul_f32 v195, v195, v191
    v_cvt_pk_bf16_f32 v171, v194, v195
    s_branch L_ghdone_48
L_ghspec_47:
    v_and_b32 v199, 1, v188
    v_lshrrev_b32 v200, 1, v188
    v_lshlrev_b32 v196, 2, v189
    s_mov_b32 s50, 0x3120
    v_lshrrev_b32 v196, v196, s50
    v_and_b32 v196, 15, v196
    v_lshlrev_b32 v196, 8, v196
    v_lshlrev_b32 v198, 10, v199
    v_cmp_eq_u32 vcc, 0, v189
    s_nop 1
    v_cndmask_b32 v196, v196, v198, vcc
    v_mov_b32 v198, 0
    v_cndmask_b32 v190, v199, v198, vcc
    v_cvt_f32_u32 v196, v196
    v_mul_f32 v196, 0x3a000000, v196
    v_cvt_f32_u32 v190, v190
    v_mul_f32 v190, 0x3e800000, v190
    v_lshrrev_b32 v198, 4, v2
    v_lshl_add_u32 v197, v198, 2, v200
    v_mov_b32 v198, 0
    v_cvt_f32_u32 v192, v3
    v_add_f32 v192, v192, v192
    v_add_f32 v193, 1.0, v192
    v_fma_f32 v192, v192, v196, v190
    v_fma_f32 v193, v193, v196, v190
    v_cos_f32 v192, v192
    v_cos_f32 v193, v193
    v_cmp_eq_u32 vcc, 0, v197
    s_nop 1
    v_cndmask_b32 v194, v198, v192, vcc
    v_cmp_eq_u32 vcc, 1, v197
    s_nop 1
    v_cndmask_b32 v195, v198, v192, vcc
    v_cvt_pk_bf16_f32 v160, v194, v195
    v_cmp_eq_u32 vcc, 2, v197
    s_nop 1
    v_cndmask_b32 v194, v198, v192, vcc
    v_cmp_eq_u32 vcc, 3, v197
    s_nop 1
    v_cndmask_b32 v195, v198, v192, vcc
    v_cvt_pk_bf16_f32 v161, v194, v195
    v_cmp_eq_u32 vcc, 0, v197
    s_nop 1
    v_cndmask_b32 v194, v198, v193, vcc
    v_cmp_eq_u32 vcc, 1, v197
    s_nop 1
    v_cndmask_b32 v195, v198, v193, vcc
    v_cvt_pk_bf16_f32 v162, v194, v195
    v_cmp_eq_u32 vcc, 2, v197
    s_nop 1
    v_cndmask_b32 v194, v198, v193, vcc
    v_cmp_eq_u32 vcc, 3, v197
    s_nop 1
    v_cndmask_b32 v195, v198, v193, vcc
    v_cvt_pk_bf16_f32 v163, v194, v195
    v_cvt_f32_u32 v192, v3
    v_add_f32 v192, v192, v192
    v_add_f32 v192, 4.0, v192
    v_add_f32 v193, 1.0, v192
    v_fma_f32 v192, v192, v196, v190
    v_fma_f32 v193, v193, v196, v190
    v_cos_f32 v192, v192
    v_cos_f32 v193, v193
    v_cmp_eq_u32 vcc, 0, v197
    s_nop 1
    v_cndmask_b32 v194, v198, v192, vcc
    v_cmp_eq_u32 vcc, 1, v197
    s_nop 1
    v_cndmask_b32 v195, v198, v192, vcc
    v_cvt_pk_bf16_f32 v204, v194, v195
    v_cmp_eq_u32 vcc, 2, v197
    s_nop 1
    v_cndmask_b32 v194, v198, v192, vcc
    v_cmp_eq_u32 vcc, 3, v197
    s_nop 1
    v_cndmask_b32 v195, v198, v192, vcc
    v_cvt_pk_bf16_f32 v205, v194, v195
    v_cmp_eq_u32 vcc, 0, v197
    s_nop 1
    v_cndmask_b32 v194, v198, v193, vcc
    v_cmp_eq_u32 vcc, 1, v197
    s_nop 1
    v_cndmask_b32 v195, v198, v193, vcc
    v_cvt_pk_bf16_f32 v206, v194, v195
    v_cmp_eq_u32 vcc, 2, v197
    s_nop 1
    v_cndmask_b32 v194, v198, v193, vcc
    v_cmp_eq_u32 vcc, 3, v197
    s_nop 1
    v_cndmask_b32 v195, v198, v193, vcc
    v_cvt_pk_bf16_f32 v207, v194, v195
    v_bfe_u32 v189, v201, 1, 2
    v_cvt_f32_u32 v196, v189
    v_mul_f32 v196, 0x3a000000, v196
    v_and_b32 v200, 1, v202
    v_and_b32 v199, 1, v201
    v_lshrrev_b32 v203, 1, v202
    v_lshrrev_b32 v198, 3, v201
    v_cmp_eq_u32 s[44:45], v203, v198
    v_cmp_eq_u32 s[46:47], v200, v199
    s_nop 3
    s_and_b64 s[44:45], s[44:45], s[46:47]
    v_cmp_eq_u32 s[46:47], 0, v200
    v_mov_b32 v192, 0x43800000
    v_mov_b32 v191, 0x00000000
    v_cndmask_b32 v192, v192, v191, s[46:47]
    v_mov_b32 v193, 0x00000000
    v_mov_b32 v191, 0x00000000
    v_cndmask_b32 v193, v193, v191, s[46:47]
    v_fma_f32 v192, v192, v196, v193
    v_cos_f32 v192, v192
    v_mov_b32 v193, 0x35800000
    v_mov_b32 v191, 0x35000000
    v_cndmask_b32 v193, v193, v191, s[46:47]
    v_mul_f32 v192, v192, v193
    v_mov_b32 v193, 0
    v_cndmask_b32 v194, v193, v192, s[44:45]
    v_mov_b32 v192, 0x43800000
    v_mov_b32 v191, 0x44800000
    v_cndmask_b32 v192, v192, v191, s[46:47]
    v_mov_b32 v193, 0x3f400000
    v_mov_b32 v191, 0x3f000000
    v_cndmask_b32 v193, v193, v191, s[46:47]
    v_fma_f32 v192, v192, v196, v193
    v_cos_f32 v192, v192
    v_mov_b32 v193, 0x35800000
    v_mov_b32 v191, 0x35000000
    v_cndmask_b32 v193, v193, v191, s[46:47]
    v_mul_f32 v192, v192, v193
    v_mov_b32 v193, 0
    v_cndmask_b32 v195, v193, v192, s[44:45]
    v_cvt_pk_bf16_f32 v164, v194, v195
    v_mov_b32 v194, 0
    v_mov_b32 v195, 0
    v_cvt_pk_bf16_f32 v165, v194, v195
    v_mov_b32 v192, 0x44400000
    v_mov_b32 v191, 0x44000000
    v_cndmask_b32 v192, v192, v191, s[46:47]
    v_mov_b32 v193, 0x00000000
    v_mov_b32 v191, 0x00000000
    v_cndmask_b32 v193, v193, v191, s[46:47]
    v_fma_f32 v192, v192, v196, v193
    v_cos_f32 v192, v192
    v_mov_b32 v193, 0x35800000
    v_mov_b32 v191, 0x35800000
    v_cndmask_b32 v193, v193, v191, s[46:47]
    v_mul_f32 v192, v192, v193
    v_mov_b32 v193, 0
    v_cndmask_b32 v194, v193, v192, s[44:45]
    v_mov_b32 v192, 0x44400000
    v_mov_b32 v191, 0x44000000
    v_cndmask_b32 v192, v192, v191, s[46:47]
    v_mov_b32 v193, 0x3f400000
    v_mov_b32 v191, 0x3f400000
    v_cndmask_b32 v193, v193, v191, s[46:47]
    v_fma_f32 v192, v192, v196, v193
    v_cos_f32 v192, v192
    v_mov_b32 v193, 0x35800000
    v_mov_b32 v191, 0x35800000
    v_cndmask_b32 v193, v193, v191, s[46:47]
    v_mul_f32 v192, v192, v193
    v_mov_b32 v193, 0
    v_cndmask_b32 v195, v193, v192, s[44:45]
    v_cvt_pk_bf16_f32 v166, v194, v195
    v_mov_b32 v194, 0
    v_mov_b32 v195, 0
    v_cvt_pk_bf16_f32 v167, v194, v195
    v_mov_b32 v194, 0
    v_mov_b32 v195, 0
    v_cvt_pk_bf16_f32 v168, v194, v195
    v_mov_b32 v192, 0x43800000
    v_mov_b32 v191, 0x00000000
    v_cndmask_b32 v192, v192, v191, s[46:47]
    v_mov_b32 v193, 0x3f000000
    v_mov_b32 v191, 0x3f000000
    v_cndmask_b32 v193, v193, v191, s[46:47]
    v_fma_f32 v192, v192, v196, v193
    v_cos_f32 v192, v192
    v_mov_b32 v193, 0x35800000
    v_mov_b32 v191, 0x35000000
    v_cndmask_b32 v193, v193, v191, s[46:47]
    v_mul_f32 v192, v192, v193
    v_mov_b32 v193, 0
    v_cndmask_b32 v194, v193, v192, s[44:45]
    v_mov_b32 v192, 0x43800000
    v_mov_b32 v191, 0x44800000
    v_cndmask_b32 v192, v192, v191, s[46:47]
    v_mov_b32 v193, 0x3fa00000
    v_mov_b32 v191, 0x3f800000
    v_cndmask_b32 v193, v193, v191, s[46:47]
    v_fma_f32 v192, v192, v196, v193
    v_cos_f32 v192, v192
    v_mov_b32 v193, 0x35800000
    v_mov_b32 v191, 0x35000000
    v_cndmask_b32 v193, v193, v191, s[46:47]
    v_mul_f32 v192, v192, v193
    v_mov_b32 v193, 0
    v_cndmask_b32 v195, v193, v192, s[44:45]
    v_cvt_pk_bf16_f32 v169, v194, v195
    v_mov_b32 v194, 0
    v_mov_b32 v195, 0
    v_cvt_pk_bf16_f32 v170, v194, v195
    v_mov_b32 v192, 0x44400000
    v_mov_b32 v191, 0x44000000
    v_cndmask_b32 v192, v192, v191, s[46:47]
    v_mov_b32 v193, 0x3f000000
    v_mov_b32 v191, 0x3f000000
    v_cndmask_b32 v193, v193, v191, s[46:47]
    v_fma_f32 v192, v192, v196, v193
    v_cos_f32 v192, v192
    v_mov_b32 v193, 0x35800000
    v_mov_b32 v191, 0x35800000
    v_cndmask_b32 v193, v193, v191, s[46:47]
    v_mul_f32 v192, v192, v193
    v_mov_b32 v193, 0
    v_cndmask_b32 v194, v193, v192, s[44:45]
    v_mov_b32 v192, 0x44400000
    v_mov_b32 v191, 0x44000000
    v_cndmask_b32 v192, v192, v191, s[46:47]
    v_mov_b32 v193, 0x3fa00000
    v_mov_b32 v191, 0x3fa00000
    v_cndmask_b32 v193, v193, v191, s[46:47]
    v_fma_f32 v192, v192, v196, v193
    v_cos_f32 v192, v192
    v_mov_b32 v193, 0x35800000
    v_mov_b32 v191, 0x35800000
    v_cndmask_b32 v193, v193, v191, s[46:47]
    v_mul_f32 v192, v192, v193
    v_mov_b32 v193, 0
    v_cndmask_b32 v195, v193, v192, s[44:45]
    v_cvt_pk_bf16_f32 v171, v194, v195
L_ghdone_48:
    s_nop 1
    s_lshl_b32 s48, s42, 3
    s_add_u32 s48, s48, s41
    s_lshl_b32 s48, s48, 6
    s_add_u32 s48, s48, 4096
    s_waitcnt lgkmcnt(0)
    s_add_u32 s101, s101, 1
    s_waitcnt vmcnt(0)
    s_barrier
    s_cmp_lg_u32 s3, 0
    s_cbranch_scc1 L_sig_49
    v_mov_b32 v240, s48
    v_mov_b32 v241, s101
    s_mov_b64 exec, 1
    buffer_store_dword v241, v240, s[28:31], 0 offen sc1
    s_mov_b64 exec, -1
L_sig_49:
L_nop1_44:
    s_setprio 2
    v_lshlrev_b32 v243, 4, v1
    s_lshl_b32 s46, s3, 12
    s_add_u32 s46, s46, 32768
    s_mov_b32 m0, s46
    s_nop 0
    buffer_load_dwordx4 v243, s[80:83], s43 offen nt lds
    s_add_u32 s93, s46, 1024
    s_mov_b32 m0, s93
    s_nop 0
    buffer_load_dwordx4 v243, s[84:87], s43 offen nt lds
    s_add_u32 s92, s72, 2
    s_add_u32 s93, s46, 2048
    s_mov_b32 m0, s93
    s_nop 0
    buffer_load_dwordx4 v243, s[80:83], s92 offen nt lds
    s_add_u32 s93, s46, 3072
    s_mov_b32 m0, s93
    s_nop 0
    buffer_load_dwordx4 v243, s[84:87], s92 offen nt lds
    v_mov_b32 v244, s72
    v_mov_b32 v245, s43
    v_add_u32 v245, 1024, v245
    buffer_load_short_d16_hi v248, v244, s[80:83], 0 offen
    buffer_load_short_d16_hi v249, v244, s[84:87], 0 offen
    buffer_load_short_d16_hi v250, v245, s[80:83], 0 offen
    buffer_load_short_d16_hi v251, v245, s[84:87], 0 offen
    s_add_u32 s32, s26, 8388608
    s_addc_u32 s33, s27, 0
    s_mov_b32 s34, 4194304
    s_mov_b32 s35, 0x00020000
    v_lshl_add_u32 v188, v3, 7, v2
    s_lshl_b32 s48, s3, 12
    s_add_u32 s48, s48, 32768
    v_lshl_add_u32 v14, v188, 1, s48
    v_sub_u32 v189, 159, v188
    s_add_u32 s49, s48, 2048
    v_lshl_add_u32 v15, v189, 1, s49
    v_lshlrev_b32 v6, 12, v3
    v_lshl_add_u32 v6, v2, 2, v6
    s_lshl_b32 s49, s3, 9
    s_lshl_b32 s52, s73, 13
    s_add_u32 s52, s52, s49
    s_lshl_b32 s53, s74, 13
    s_add_u32 s53, s53, s49
    s_lshl_b32 s54, s40, 14
    s_add_u32 s54, s54, s49
    s_sub_u32 s55, 256, s40
    s_and_b32 s55, s55, 255
    s_lshl_b32 s55, s55, 14
    s_add_u32 s55, s55, s49
    s_add_u32 s56, s54, 8192
    s_add_u32 s57, s55, 8192
    v_lshlrev_b32 v7, 12, v3
    v_lshl_add_u32 v7, v2, 3, v7
    s_lshl_b32 s50, s3, 10
    v_add_u32 v7, s50, v7
    v_lshlrev_b32 v8, 9, v3
    v_lshl_add_u32 v8, v2, 2, v8
    s_lshl_b32 s51, s3, 12
    v_add_u32 v8, s51, v8
    v_add_u32 v9, 1024, v8
    v_add_u32 v10, 2048, v8
    v_add_u32 v11, 3072, v8
    v_lshrrev_b32 v188, 4, v1
    v_and_b32 v189, 1, v188
    v_lshlrev_b32 v12, 13, v189
    v_lshrrev_b32 v189, 1, v188
    v_lshl_add_u32 v12, v189, 7, v12
    v_and_b32 v189, 15, v1
    v_lshl_add_u32 v12, v189, 3, v12
    v_add_u32 v12, s50, v12
    v_and_b32 v190, 1, v189
    v_mov_b32 v191, s52
    v_mov_b32 v192, s53
    v_cmp_eq_u32 vcc, 1, v190
    s_nop 1
    v_cndmask_b32 v13, v191, v192, vcc
    v_bfe_u32 v190, v189, 1, 2
    v_lshl_add_u32 v13, v190, 11, v13
    v_lshrrev_b32 v190, 3, v189
    v_lshl_add_u32 v13, v190, 6, v13
    v_lshl_add_u32 v13, v188, 4, v13
    v_lshlrev_b32 v188, 6, v1
    v_add_u32 v188, 4096, v188
    s_lshl_b32 s48, s3, 12
    v_add_u32 v188, s48, v188
    s_mov_b32 s48, 0
L_poll_50:
    buffer_load_dword v189, v188, s[28:31], 0 offen sc1
    s_add_u32 s48, s48, 1
    s_waitcnt vmcnt(0)
    v_xor_b32 v189, s101, v189
    v_cmp_ne_u32 vcc, 0, v189
    s_cbranch_vccz L_prest_52
    s_cmp_lt_u32 s48, 400000
    s_cbranch_scc1 L_poll_50
L_prest_52:
L_pdone_51:
    buffer_load_dword v172, v6, s[36:39], s54 offen offset:0 sc1
    buffer_load_dword v173, v6, s[36:39], s55 offen offset:0 sc1
    buffer_load_dword v174, v6, s[36:39], s54 offen offset:2048 sc1
    buffer_load_dword v175, v6, s[36:39], s55 offen offset:2048 sc1
    buffer_load_dword v176, v6, s[36:39], s56 offen offset:0 sc1
    buffer_load_dword v177, v6, s[36:39], s57 offen offset:0 sc1
    buffer_load_dword v178, v6, s[36:39], s56 offen offset:2048 sc1
    buffer_load_dword v179, v6, s[36:39], s57 offen offset:2048 sc1
    buffer_load_dword v180, v6, s[36:39], s54 offen offset:128 sc1
    buffer_load_dword v181, v6, s[36:39], s55 offen offset:128 sc1
    buffer_load_dword v182, v6, s[36:39], s54 offen offset:2176 sc1
    buffer_load_dword v183, v6, s[36:39], s55 offen offset:2176 sc1
    buffer_load_dword v184, v6, s[36:39], s56 offen offset:128 sc1
    buffer_load_dword v185, v6, s[36:39], s57 offen offset:128 sc1
    buffer_load_dword v186, v6, s[36:39], s56 offen offset:2176 sc1
    buffer_load_dword v187, v6, s[36:39], s57 offen offset:2176 sc1
    buffer_load_dword v144, v6, s[36:39], s54 offen offset:256 sc1
    buffer_load_dword v145, v6, s[36:39], s55 offen offset:256 sc1
    buffer_load_dword v146, v6, s[36:39], s54 offen offset:2304 sc1
    buffer_load_dword v147, v6, s[36:39], s55 offen offset:2304 sc1
    buffer_load_dword v148, v6, s[36:39], s56 offen offset:256 sc1
    buffer_load_dword v149, v6, s[36:39], s57 offen offset:256 sc1
    buffer_load_dword v150, v6, s[36:39], s56 offen offset:2304 sc1
    buffer_load_dword v151, v6, s[36:39], s57 offen offset:2304 sc1
    buffer_load_dword v152, v6, s[36:39], s54 offen offset:384 sc1
    buffer_load_dword v153, v6, s[36:39], s55 offen offset:384 sc1
    buffer_load_dword v154, v6, s[36:39], s54 offen offset:2432 sc1
    buffer_load_dword v155, v6, s[36:39], s55 offen offset:2432 sc1
    buffer_load_dword v156, v6, s[36:39], s56 offen offset:384 sc1
    buffer_load_dword v157, v6, s[36:39], s57 offen offset:384 sc1
    buffer_load_dword v158, v6, s[36:39], s56 offen offset:2432 sc1
    buffer_load_dword v159, v6, s[36:39], s57 offen offset:2432 sc1
    s_waitcnt vmcnt(16)
    v_mfma_f32_32x32x16_bf16 v[112:127], v[160:163], v[172:175], 0
    v_mfma_f32_32x32x16_bf16 v[112:127], v[204:207], v[176:179], v[112:127]
    v_mfma_f32_32x32x16_bf16 v[128:143], v[160:163], v[180:183], 0
    v_mfma_f32_32x32x16_bf16 v[128:143], v[204:207], v[184:187], v[128:143]
    s_nop 9
    v_cvt_pk_bf16_f32 v188, v112, v113
    v_cvt_pk_bf16_f32 v189, v114, v115
    ds_write_b64 v7, v[188:189] offset:0
    v_cvt_pk_bf16_f32 v190, v116, v117
    v_cvt_pk_bf16_f32 v191, v118, v119
    ds_write_b64 v7, v[190:191] offset:8192
    v_cvt_pk_bf16_f32 v192, v128, v129
    v_cvt_pk_bf16_f32 v193, v130, v131
    ds_write_b64 v7, v[192:193] offset:256
    v_cvt_pk_bf16_f32 v194, v132, v133
    v_cvt_pk_bf16_f32 v195, v134, v135
    ds_write_b64 v7, v[194:195] offset:8448
    s_waitcnt vmcnt(0)
    v_mfma_f32_32x32x16_bf16 v[112:127], v[160:163], v[144:147], 0
    v_mfma_f32_32x32x16_bf16 v[112:127], v[204:207], v[148:151], v[112:127]
    v_mfma_f32_32x32x16_bf16 v[128:143], v[160:163], v[152:155], 0
    v_mfma_f32_32x32x16_bf16 v[128:143], v[204:207], v[156:159], v[128:143]
    s_nop 9
    v_cvt_pk_bf16_f32 v188, v112, v113
    v_cvt_pk_bf16_f32 v189, v114, v115
    ds_write_b64 v7, v[188:189] offset:512
    v_cvt_pk_bf16_f32 v190, v116, v117
    v_cvt_pk_bf16_f32 v191, v118, v119
    ds_write_b64 v7, v[190:191] offset:8704
    v_cvt_pk_bf16_f32 v192, v128, v129
    v_cvt_pk_bf16_f32 v193, v130, v131
    ds_write_b64 v7, v[192:193] offset:768
    v_cvt_pk_bf16_f32 v194, v132, v133
    v_cvt_pk_bf16_f32 v195, v134, v135
    ds_write_b64 v7, v[194:195] offset:8960
    s_waitcnt lgkmcnt(0)
    s_barrier
    ds_read2_b32 v[144:145], v8 offset0:0 offset1:32
    ds_read2_b32 v[146:147], v8 offset0:64 offset1:96
    ds_read2_b32 v[148:149], v9 offset0:0 offset1:32
    ds_read2_b32 v[150:151], v9 offset0:64 offset1:96
    ds_read2_b32 v[152:153], v10 offset0:0 offset1:32
    ds_read2_b32 v[154:155], v10 offset0:64 offset1:96
    ds_read2_b32 v[156:157], v11 offset0:0 offset1:32
    ds_read2_b32 v[158:159], v11 offset0:64 offset1:96
    s_waitcnt lgkmcnt(0)
    s_mov_b32 s45, 0
    s_cmp_lg_u32 s75, 0
    s_cbranch_scc1 L_pre_56
    v_lshrrev_b32 v172, 16, v144
    v_and_b32 v144, 0xffff, v144
    v_lshrrev_b32 v173, 16, v145
    v_and_b32 v145, 0xffff, v145
    v_lshrrev_b32 v174, 16, v146
    v_and_b32 v146, 0xffff, v146
    v_lshrrev_b32 v175, 16, v147
    v_and_b32 v147, 0xffff, v147
    v_lshrrev_b32 v176, 16, v148
    v_and_b32 v148, 0xffff, v148
    v_lshrrev_b32 v177, 16, v149
    v_and_b32 v149, 0xffff, v149
    v_lshrrev_b32 v178, 16, v150
    v_and_b32 v150, 0xffff, v150
    v_lshrrev_b32 v179, 16, v151
    v_and_b32 v151, 0xffff, v151
    v_lshrrev_b32 v180, 16, v152
    v_and_b32 v152, 0xffff, v152
    v_lshrrev_b32 v181, 16, v153
    v_and_b32 v153, 0xffff, v153
    v_lshrrev_b32 v182, 16, v154
    v_and_b32 v154, 0xffff, v154
    v_lshrrev_b32 v183, 16, v155
    v_and_b32 v155, 0xffff, v155
    v_lshrrev_b32 v184, 16, v156
    v_and_b32 v156, 0xffff, v156
    v_lshrrev_b32 v185, 16, v157
    v_and_b32 v157, 0xffff, v157
    v_lshrrev_b32 v186, 16, v158
    v_and_b32 v158, 0xffff, v158
    v_lshrrev_b32 v187, 16, v159
    v_and_b32 v159, 0xffff, v159
L_pre_56:
    ds_read_u16_d16_hi v80, v14 offset:0
    ds_read_u16_d16_hi v81, v14 offset:64
    ds_read_u16_d16_hi v82, v14 offset:128
    ds_read_u16_d16_hi v83, v14 offset:192
    ds_read_u16_d16_hi v84, v14 offset:512
    ds_read_u16_d16_hi v85, v14 offset:576
    ds_read_u16_d16_hi v86, v14 offset:640
    ds_read_u16_d16_hi v87, v14 offset:704
    ds_read_u16_d16_hi v88, v15 offset:704
    ds_read_u16_d16_hi v89, v15 offset:640
    ds_read_u16_d16_hi v90, v15 offset:576
    ds_read_u16_d16_hi v91, v15 offset:512
    ds_read_u16_d16_hi v92, v15 offset:192
    ds_read_u16_d16_hi v93, v15 offset:128
    ds_read_u16_d16_hi v94, v15 offset:64
    ds_read_u16_d16_hi v95, v15 offset:0
    ds_read_u16_d16_hi v96, v14 offset:1024
    ds_read_u16_d16_hi v97, v14 offset:1088
    ds_read_u16_d16_hi v98, v14 offset:1152
    ds_read_u16_d16_hi v99, v14 offset:1216
    ds_read_u16_d16_hi v100, v14 offset:1536
    ds_read_u16_d16_hi v101, v14 offset:1600
    ds_read_u16_d16_hi v102, v14 offset:1664
    ds_read_u16_d16_hi v103, v14 offset:1728
    ds_read_u16_d16_hi v104, v15 offset:1728
    ds_read_u16_d16_hi v105, v15 offset:1664
    ds_read_u16_d16_hi v106, v15 offset:1600
    ds_read_u16_d16_hi v107, v15 offset:1536
    ds_read_u16_d16_hi v108, v15 offset:1216
    ds_read_u16_d16_hi v109, v15 offset:1152
    ds_read_u16_d16_hi v110, v15 offset:1088
    ds_read_u16_d16_hi v111, v15 offset:1024
L_fwd_55:
    s_nop 1
    v_mfma_f32_32x32x16_bf16 v[112:127], v[144:147], v[16:19], 0
    v_mfma_f32_32x32x16_bf16 v[128:143], v[144:147], v[32:35], 0
    v_mfma_f32_32x32x16_bf16 v[112:127], v[148:151], v[20:23], v[112:127]
    v_mfma_f32_32x32x16_bf16 v[128:143], v[148:151], v[36:39], v[128:143]
    v_mfma_f32_32x32x16_bf16 v[112:127], v[152:155], v[24:27], v[112:127]
    v_mfma_f32_32x32x16_bf16 v[128:143], v[152:155], v[40:43], v[128:143]
    v_mfma_f32_32x32x16_bf16 v[112:127], v[156:159], v[28:31], v[112:127]
    v_mfma_f32_32x32x16_bf16 v[128:143], v[156:159], v[44:47], v[128:143]
    s_nop 10
    v_pk_mul_f32 v[188:189], v[112:113], v[48:49]
    v_pk_mul_f32 v[190:191], v[128:129], v[48:49]
    v_pk_fma_f32 v[188:189], v[128:129], v[64:65], v[188:189]
    v_pk_fma_f32 v[190:191], v[112:113], v[64:65], v[190:191] neg_lo:[1,0,0] neg_hi:[1,0,0]
    v_cvt_pk_bf16_f32 v144, v188, v190
    v_cvt_pk_bf16_f32 v145, v189, v191
    v_pk_mul_f32 v[192:193], v[114:115], v[50:51]
    v_pk_mul_f32 v[194:195], v[130:131], v[50:51]
    v_pk_fma_f32 v[192:193], v[130:131], v[66:67], v[192:193]
    v_pk_fma_f32 v[194:195], v[114:115], v[66:67], v[194:195] neg_lo:[1,0,0] neg_hi:[1,0,0]
    v_cvt_pk_bf16_f32 v146, v192, v194
    v_cvt_pk_bf16_f32 v147, v193, v195
    v_pk_mul_f32 v[188:189], v[116:117], v[52:53]
    v_pk_mul_f32 v[190:191], v[132:133], v[52:53]
    v_pk_fma_f32 v[188:189], v[132:133], v[68:69], v[188:189]
    v_pk_fma_f32 v[190:191], v[116:117], v[68:69], v[190:191] neg_lo:[1,0,0] neg_hi:[1,0,0]
    v_cvt_pk_bf16_f32 v148, v188, v190
    v_cvt_pk_bf16_f32 v149, v189, v191
    v_pk_mul_f32 v[192:193], v[118:119], v[54:55]
    v_pk_mul_f32 v[194:195], v[134:135], v[54:55]
    v_pk_fma_f32 v[192:193], v[134:135], v[70:71], v[192:193]
    v_pk_fma_f32 v[194:195], v[118:119], v[70:71], v[194:195] neg_lo:[1,0,0] neg_hi:[1,0,0]
    v_cvt_pk_bf16_f32 v150, v192, v194
    v_cvt_pk_bf16_f32 v151, v193, v195
    v_pk_mul_f32 v[188:189], v[120:121], v[56:57]
    v_pk_mul_f32 v[190:191], v[136:137], v[56:57]
    v_pk_fma_f32 v[188:189], v[136:137], v[72:73], v[188:189]
    v_pk_fma_f32 v[190:191], v[120:121], v[72:73], v[190:191] neg_lo:[1,0,0] neg_hi:[1,0,0]
    v_cvt_pk_bf16_f32 v152, v188, v190
    v_cvt_pk_bf16_f32 v153, v189, v191
    v_pk_mul_f32 v[192:193], v[122:123], v[58:59]
    v_pk_mul_f32 v[194:195], v[138:139], v[58:59]
    v_pk_fma_f32 v[192:193], v[138:139], v[74:75], v[192:193]
    v_pk_fma_f32 v[194:195], v[122:123], v[74:75], v[194:195] neg_lo:[1,0,0] neg_hi:[1,0,0]
    v_cvt_pk_bf16_f32 v154, v192, v194
    v_cvt_pk_bf16_f32 v155, v193, v195
    v_pk_mul_f32 v[188:189], v[124:125], v[60:61]
    v_pk_mul_f32 v[190:191], v[140:141], v[60:61]
    v_pk_fma_f32 v[188:189], v[140:141], v[76:77], v[188:189]
    v_pk_fma_f32 v[190:191], v[124:125], v[76:77], v[190:191] neg_lo:[1,0,0] neg_hi:[1,0,0]
    v_cvt_pk_bf16_f32 v156, v188, v190
    v_cvt_pk_bf16_f32 v157, v189, v191
    v_pk_mul_f32 v[192:193], v[126:127], v[62:63]
    v_pk_mul_f32 v[194:195], v[142:143], v[62:63]
    v_pk_fma_f32 v[192:193], v[142:143], v[78:79], v[192:193]
    v_pk_fma_f32 v[194:195], v[126:127], v[78:79], v[194:195] neg_lo:[1,0,0] neg_hi:[1,0,0]
    v_cvt_pk_bf16_f32 v158, v192, v194
    v_cvt_pk_bf16_f32 v159, v193, v195
    v_mfma_f32_32x32x16_bf16 v[112:127], v[16:19], v[144:147], 0
    v_mfma_f32_32x32x16_bf16 v[128:143], v[32:35], v[144:147], 0
    v_mfma_f32_32x32x16_bf16 v[112:127], v[20:23], v[148:151], v[112:127]
    v_mfma_f32_32x32x16_bf16 v[128:143], v[36:39], v[148:151], v[128:143]
    v_mfma_f32_32x32x16_bf16 v[112:127], v[24:27], v[152:155], v[112:127]
    v_mfma_f32_32x32x16_bf16 v[128:143], v[40:43], v[152:155], v[128:143]
    v_mfma_f32_32x32x16_bf16 v[112:127], v[28:31], v[156:159], v[112:127]
    v_mfma_f32_32x32x16_bf16 v[128:143], v[44:47], v[156:159], v[128:143]
    s_waitcnt lgkmcnt(0)
    s_cmp_lg_u32 s45, 0
    s_cbranch_scc1 L_nofix_58
    v_cmp_eq_u32 vcc, 0, v1
    v_add_f32 v188, v80, v248
    v_mul_f32 v188, 0.5, v188
    v_sub_f32 v189, v96, v249
    v_mul_f32 v189, 0.5, v189
    v_cndmask_b32 v80, v80, v188, vcc
    v_cndmask_b32 v96, v96, v189, vcc
    v_add_f32 v188, v88, v250
    v_mul_f32 v188, 0.5, v188
    v_sub_f32 v189, v104, v251
    v_mul_f32 v189, 0.5, v189
    v_cndmask_b32 v88, v88, v188, vcc
    v_cndmask_b32 v104, v104, v189, vcc
L_nofix_58:
    s_cmp_eq_u32 s75, 0
    s_cbranch_scc1 L_special_53
    v_pk_mul_f32 v[188:189], v[112:113], v[80:81]
    v_pk_mul_f32 v[190:191], v[128:129], v[80:81]
    v_pk_fma_f32 v[188:189], v[128:129], v[96:97], v[188:189] neg_lo:[1,0,0] neg_hi:[1,0,0]
    v_pk_fma_f32 v[190:191], v[112:113], v[96:97], v[190:191]
    v_cvt_pk_bf16_f32 v144, v188, -v190
    v_cvt_pk_bf16_f32 v145, v189, -v191
    v_pk_mul_f32 v[192:193], v[114:115], v[82:83]
    v_pk_mul_f32 v[194:195], v[130:131], v[82:83]
    v_pk_fma_f32 v[192:193], v[130:131], v[98:99], v[192:193] neg_lo:[1,0,0] neg_hi:[1,0,0]
    v_pk_fma_f32 v[194:195], v[114:115], v[98:99], v[194:195]
    v_cvt_pk_bf16_f32 v146, v192, -v194
    v_cvt_pk_bf16_f32 v147, v193, -v195
    v_pk_mul_f32 v[188:189], v[116:117], v[84:85]
    v_pk_mul_f32 v[190:191], v[132:133], v[84:85]
    v_pk_fma_f32 v[188:189], v[132:133], v[100:101], v[188:189] neg_lo:[1,0,0] neg_hi:[1,0,0]
    v_pk_fma_f32 v[190:191], v[116:117], v[100:101], v[190:191]
    v_cvt_pk_bf16_f32 v148, v188, -v190
    v_cvt_pk_bf16_f32 v149, v189, -v191
    v_pk_mul_f32 v[192:193], v[118:119], v[86:87]
    v_pk_mul_f32 v[194:195], v[134:135], v[86:87]
    v_pk_fma_f32 v[192:193], v[134:135], v[102:103], v[192:193] neg_lo:[1,0,0] neg_hi:[1,0,0]
    v_pk_fma_f32 v[194:195], v[118:119], v[102:103], v[194:195]
    v_cvt_pk_bf16_f32 v150, v192, -v194
    v_cvt_pk_bf16_f32 v151, v193, -v195
    v_pk_mul_f32 v[188:189], v[120:121], v[88:89]
    v_pk_mul_f32 v[190:191], v[136:137], v[88:89]
    v_pk_fma_f32 v[188:189], v[136:137], v[104:105], v[188:189]
    v_pk_fma_f32 v[190:191], v[120:121], v[104:105], v[190:191] neg_lo:[1,0,0] neg_hi:[1,0,0]
    v_cvt_pk_bf16_f32 v152, v188, -v190
    v_cvt_pk_bf16_f32 v153, v189, -v191
    v_pk_mul_f32 v[192:193], v[122:123], v[90:91]
    v_pk_mul_f32 v[194:195], v[138:139], v[90:91]
    v_pk_fma_f32 v[192:193], v[138:139], v[106:107], v[192:193]
    v_pk_fma_f32 v[194:195], v[122:123], v[106:107], v[194:195] neg_lo:[1,0,0] neg_hi:[1,0,0]
    v_cvt_pk_bf16_f32 v154, v192, -v194
    v_cvt_pk_bf16_f32 v155, v193, -v195
    v_pk_mul_f32 v[188:189], v[124:125], v[92:93]
    v_pk_mul_f32 v[190:191], v[140:141], v[92:93]
    v_pk_fma_f32 v[188:189], v[140:141], v[108:109], v[188:189]
    v_pk_fma_f32 v[190:191], v[124:125], v[108:109], v[190:191] neg_lo:[1,0,0] neg_hi:[1,0,0]
    v_cvt_pk_bf16_f32 v156, v188, -v190
    v_cvt_pk_bf16_f32 v157, v189, -v191
    v_pk_mul_f32 v[192:193], v[126:127], v[94:95]
    v_pk_mul_f32 v[194:195], v[142:143], v[94:95]
    v_pk_fma_f32 v[192:193], v[142:143], v[110:111], v[192:193]
    v_pk_fma_f32 v[194:195], v[126:127], v[110:111], v[194:195] neg_lo:[1,0,0] neg_hi:[1,0,0]
    v_cvt_pk_bf16_f32 v158, v192, -v194
    v_cvt_pk_bf16_f32 v159, v193, -v195
L_inv_54:
    s_nop 1
    v_mfma_f32_32x32x16_bf16 v[112:127], v[144:147], v[16:19], 0
    v_mfma_f32_32x32x16_bf16 v[128:143], v[144:147], v[32:35], 0
    v_mfma_f32_32x32x16_bf16 v[112:127], v[148:151], v[20:23], v[112:127]
    v_mfma_f32_32x32x16_bf16 v[128:143], v[148:151], v[36:39], v[128:143]
    v_mfma_f32_32x32x16_bf16 v[112:127], v[152:155], v[24:27], v[112:127]
    v_mfma_f32_32x32x16_bf16 v[128:143], v[152:155], v[40:43], v[128:143]
    v_mfma_f32_32x32x16_bf16 v[112:127], v[156:159], v[28:31], v[112:127]
    v_mfma_f32_32x32x16_bf16 v[128:143], v[156:159], v[44:47], v[128:143]
    s_nop 10
    v_pk_mul_f32 v[188:189], v[112:113], v[48:49]
    v_pk_mul_f32 v[190:191], v[128:129], v[48:49]
    v_pk_fma_f32 v[188:189], v[128:129], v[64:65], v[188:189]
    v_pk_fma_f32 v[190:191], v[112:113], v[64:65], v[190:191] neg_lo:[1,0,0] neg_hi:[1,0,0]
    v_cvt_pk_bf16_f32 v144, v188, v190
    v_cvt_pk_bf16_f32 v145, v189, v191
    v_pk_mul_f32 v[192:193], v[114:115], v[50:51]
    v_pk_mul_f32 v[194:195], v[130:131], v[50:51]
    v_pk_fma_f32 v[192:193], v[130:131], v[66:67], v[192:193]
    v_pk_fma_f32 v[194:195], v[114:115], v[66:67], v[194:195] neg_lo:[1,0,0] neg_hi:[1,0,0]
    v_cvt_pk_bf16_f32 v146, v192, v194
    v_cvt_pk_bf16_f32 v147, v193, v195
    v_pk_mul_f32 v[188:189], v[116:117], v[52:53]
    v_pk_mul_f32 v[190:191], v[132:133], v[52:53]
    v_pk_fma_f32 v[188:189], v[132:133], v[68:69], v[188:189]
    v_pk_fma_f32 v[190:191], v[116:117], v[68:69], v[190:191] neg_lo:[1,0,0] neg_hi:[1,0,0]
    v_cvt_pk_bf16_f32 v148, v188, v190
    v_cvt_pk_bf16_f32 v149, v189, v191
    v_pk_mul_f32 v[192:193], v[118:119], v[54:55]
    v_pk_mul_f32 v[194:195], v[134:135], v[54:55]
    v_pk_fma_f32 v[192:193], v[134:135], v[70:71], v[192:193]
    v_pk_fma_f32 v[194:195], v[118:119], v[70:71], v[194:195] neg_lo:[1,0,0] neg_hi:[1,0,0]
    v_cvt_pk_bf16_f32 v150, v192, v194
    v_cvt_pk_bf16_f32 v151, v193, v195
    v_pk_mul_f32 v[188:189], v[120:121], v[56:57]
    v_pk_mul_f32 v[190:191], v[136:137], v[56:57]
    v_pk_fma_f32 v[188:189], v[136:137], v[72:73], v[188:189]
    v_pk_fma_f32 v[190:191], v[120:121], v[72:73], v[190:191] neg_lo:[1,0,0] neg_hi:[1,0,0]
    v_cvt_pk_bf16_f32 v152, v188, v190
    v_cvt_pk_bf16_f32 v153, v189, v191
    v_pk_mul_f32 v[192:193], v[122:123], v[58:59]
    v_pk_mul_f32 v[194:195], v[138:139], v[58:59]
    v_pk_fma_f32 v[192:193], v[138:139], v[74:75], v[192:193]
    v_pk_fma_f32 v[194:195], v[122:123], v[74:75], v[194:195] neg_lo:[1,0,0] neg_hi:[1,0,0]
    v_cvt_pk_bf16_f32 v154, v192, v194
    v_cvt_pk_bf16_f32 v155, v193, v195
    v_pk_mul_f32 v[188:189], v[124:125], v[60:61]
    v_pk_mul_f32 v[190:191], v[140:141], v[60:61]
    v_pk_fma_f32 v[188:189], v[140:141], v[76:77], v[188:189]
    v_pk_fma_f32 v[190:191], v[124:125], v[76:77], v[190:191] neg_lo:[1,0,0] neg_hi:[1,0,0]
    v_cvt_pk_bf16_f32 v156, v188, v190
    v_cvt_pk_bf16_f32 v157, v189, v191
    v_pk_mul_f32 v[192:193], v[126:127], v[62:63]
    v_pk_mul_f32 v[194:195], v[142:143], v[62:63]
    v_pk_fma_f32 v[192:193], v[142:143], v[78:79], v[192:193]
    v_pk_fma_f32 v[194:195], v[126:127], v[78:79], v[194:195] neg_lo:[1,0,0] neg_hi:[1,0,0]
    v_cvt_pk_bf16_f32 v158, v192, v194
    v_cvt_pk_bf16_f32 v159, v193, v195
    v_mfma_f32_32x32x16_bf16 v[112:127], v[16:19], v[144:147], 0
    v_mfma_f32_32x32x16_bf16 v[128:143], v[32:35], v[144:147], 0
    v_mfma_f32_32x32x16_bf16 v[112:127], v[20:23], v[148:151], v[112:127]
    v_mfma_f32_32x32x16_bf16 v[128:143], v[36:39], v[148:151], v[128:143]
    v_mfma_f32_32x32x16_bf16 v[112:127], v[24:27], v[152:155], v[112:127]
    v_mfma_f32_32x32x16_bf16 v[128:143], v[40:43], v[152:155], v[128:143]
    v_mfma_f32_32x32x16_bf16 v[112:127], v[28:31], v[156:159], v[112:127]
    v_mfma_f32_32x32x16_bf16 v[128:143], v[44:47], v[156:159], v[128:143]
    s_nop 11
    v_cvt_pk_bf16_f32 v188, v112, v128
    ds_write_b32 v8, v188 offset:0
    v_cvt_pk_bf16_f32 v189, v113, v129
    ds_write_b32 v8, v189 offset:128
    v_cvt_pk_bf16_f32 v190, v114, v130
    ds_write_b32 v8, v190 offset:256
    v_cvt_pk_bf16_f32 v191, v115, v131
    ds_write_b32 v8, v191 offset:384
    v_cvt_pk_bf16_f32 v192, v116, v132
    ds_write_b32 v8, v192 offset:1024
    v_cvt_pk_bf16_f32 v193, v117, v133
    ds_write_b32 v8, v193 offset:1152
    v_cvt_pk_bf16_f32 v194, v118, v134
    ds_write_b32 v8, v194 offset:1280
    v_cvt_pk_bf16_f32 v195, v119, v135
    ds_write_b32 v8, v195 offset:1408
    v_cvt_pk_bf16_f32 v188, v120, v136
    ds_write_b32 v8, v188 offset:2048
    v_cvt_pk_bf16_f32 v189, v121, v137
    ds_write_b32 v8, v189 offset:2176
    v_cvt_pk_bf16_f32 v190, v122, v138
    ds_write_b32 v8, v190 offset:2304
    v_cvt_pk_bf16_f32 v191, v123, v139
    ds_write_b32 v8, v191 offset:2432
    v_cvt_pk_bf16_f32 v192, v124, v140
    ds_write_b32 v8, v192 offset:3072
    v_cvt_pk_bf16_f32 v193, v125, v141
    ds_write_b32 v8, v193 offset:3200
    v_cvt_pk_bf16_f32 v194, v126, v142
    ds_write_b32 v8, v194 offset:3328
    v_cvt_pk_bf16_f32 v195, v127, v143
    ds_write_b32 v8, v195 offset:3456
L_join_57:
    s_waitcnt lgkmcnt(0)
    s_barrier
    ds_read_b64 v[172:173], v12 offset:0
    ds_read_b64 v[174:175], v12 offset:4096
    ds_read_b64 v[176:177], v12 offset:256
    ds_read_b64 v[178:179], v12 offset:4352
    ds_read_b64 v[180:181], v12 offset:512
    ds_read_b64 v[182:183], v12 offset:4608
    ds_read_b64 v[184:185], v12 offset:768
    ds_read_b64 v[186:187], v12 offset:4864
    s_lshl_b32 s49, s3, 9
    s_waitcnt lgkmcnt(6)
    v_mfma_f32_16x16x32_bf16 v[112:115], v[172:175], v[164:167], 0
    v_mfma_f32_16x16x32_bf16 v[128:131], v[172:175], v[168:171], 0
    s_waitcnt lgkmcnt(4)
    v_mfma_f32_16x16x32_bf16 v[116:119], v[176:179], v[164:167], 0
    v_mfma_f32_16x16x32_bf16 v[132:135], v[176:179], v[168:171], 0
    s_waitcnt lgkmcnt(2)
    v_mfma_f32_16x16x32_bf16 v[120:123], v[180:183], v[164:167], 0
    v_mfma_f32_16x16x32_bf16 v[136:139], v[180:183], v[168:171], 0
    s_waitcnt lgkmcnt(0)
    v_mfma_f32_16x16x32_bf16 v[124:127], v[184:187], v[164:167], 0
    v_mfma_f32_16x16x32_bf16 v[140:143], v[184:187], v[168:171], 0
    v_cvt_pk_bf16_f32 v144, v112, v128
    v_cvt_pk_bf16_f32 v145, v113, v129
    v_cvt_pk_bf16_f32 v146, v114, v130
    v_cvt_pk_bf16_f32 v147, v115, v131
    buffer_store_dwordx4 v[144:147], v13, s[32:35], 0 offen offset:0 sc1
    v_cvt_pk_bf16_f32 v148, v116, v132
    v_cvt_pk_bf16_f32 v149, v117, v133
    v_cvt_pk_bf16_f32 v150, v118, v134
    v_cvt_pk_bf16_f32 v151, v119, v135
    buffer_store_dwordx4 v[148:151], v13, s[32:35], 0 offen offset:128 sc1
    v_cvt_pk_bf16_f32 v152, v120, v136
    v_cvt_pk_bf16_f32 v153, v121, v137
    v_cvt_pk_bf16_f32 v154, v122, v138
    v_cvt_pk_bf16_f32 v155, v123, v139
    buffer_store_dwordx4 v[152:155], v13, s[32:35], 0 offen offset:256 sc1
    v_cvt_pk_bf16_f32 v156, v124, v140
    v_cvt_pk_bf16_f32 v157, v125, v141
    v_cvt_pk_bf16_f32 v158, v126, v142
    v_cvt_pk_bf16_f32 v159, v127, v143
    buffer_store_dwordx4 v[156:159], v13, s[32:35], 0 offen offset:384 sc1
    s_lshl_b32 s48, s40, 6
    s_add_u32 s48, s48, 20480
    s_waitcnt vmcnt(0)
    s_barrier
    s_cmp_lg_u32 s3, 0
    s_cbranch_scc1 L_sig_59
    v_mov_b32 v188, s48
    v_mov_b32 v189, s101
    s_mov_b64 exec, 1
    buffer_store_dword v189, v188, s[28:31], 0 offen sc1
    s_mov_b64 exec, -1
L_sig_59:
    s_mov_b32 s36, s22
    s_mov_b32 s37, s23
    s_mov_b32 s38, 8388608
    s_mov_b32 s39, 0x00020000
    s_lshr_b32 s48, s91, 3
    s_and_b32 s49, s91, 7
    s_lshr_b32 s41, s48, 3
    s_bfe_u32 s50, s48, 0x10002
    s_lshl_b32 s50, s50, 3
    s_add_u32 s50, s50, s49
    s_lshl_b32 s50, s50, 2
    s_and_b32 s51, s48, 3
    s_add_u32 s42, s50, s51
    v_and_b32 v2, 15, v1
    v_lshrrev_b32 v3, 4, v1
    v_and_b32 v11, 7, v1
    v_bfe_u32 v12, v1, 3, 1
    v_lshlrev_b32 v4, 20, v3
    v_lshl_add_u32 v4, v12, 15, v4
    v_lshl_add_u32 v4, v11, 2, v4
    s_lshl_b32 s48, s41, 11
    s_lshl_b32 s49, s42, 5
    s_add_u32 s48, s48, s49
    s_lshl_b32 s50, s3, 16
    s_add_u32 s48, s48, s50
    s_add_u32 s52, s48, 0
    s_add_u32 s53, s48, 262144
    s_add_u32 s54, s48, 524288
    s_add_u32 s55, s48, 786432
    s_add_u32 s56, s48, 8192
    s_add_u32 s57, s48, 270336
    s_add_u32 s58, s48, 532480
    s_add_u32 s59, s48, 794624
    s_add_u32 s60, s48, 16384
    s_add_u32 s61, s48, 278528
    s_add_u32 s62, s48, 540672
    s_add_u32 s63, s48, 802816
    s_add_u32 s64, s48, 24576
    s_add_u32 s65, s48, 286720
    s_add_u32 s66, s48, 548864
    s_add_u32 s67, s48, 811008
    v_lshrrev_b32 v13, 1, v3
    v_lshl_add_u32 v13, v2, 4, v13
    s_mov_b32 s51, 16384
    v_mul_lo_u32 v6, v13, s51
    v_and_b32 v13, 1, v3
    v_lshl_add_u32 v6, v13, 4, v6
    s_mul_i32 s48, s41, 4096
    s_lshl_b32 s49, s42, 5
    s_add_u32 s48, s48, s49
    s_mul_i32 s50, s3, 65536
    s_add_u32 s48, s48, s50
    s_add_u32 s68, s48, 0
    s_add_u32 s69, s48, 4194304
    s_add_u32 s70, s48, 32768
    s_add_u32 s71, s48, 4227072
    s_lshl_b32 s50, s3, 1
    v_add_u32 v13, s50, v12
    v_xor_b32 v13, v13, v11
    v_lshlrev_b32 v7, 4, v13
    v_lshl_add_u32 v7, v11, 7, v7
    v_lshl_add_u32 v7, v3, 12, v7
    v_xor_b32 v13, v3, v11
    v_lshlrev_b32 v8, 4, v13
    v_lshl_add_u32 v8, v11, 7, v8
    v_lshl_add_u32 v8, v12, 10, v8
    s_lshl_b32 s50, s3, 12
    v_add_u32 v8, s50, v8
    v_xor_b32 v9, 64, v8
    v_cvt_f32_u32 v11, v2
    v_mul_f32 v11, 0x3d000000, v11
    v_cvt_f32_u32 v13, v3
    v_mul_f32 v13, 4.0, v13
    v_mul_f32 v12, v13, v11
    v_and_b32 v10, 1, v2
    v_mul_u32_u24 v10, 0x8000, v10
    v_lshl_or_b32 v10, v10, 16, v10
    s_mov_b32 s50, 0x80008000
    v_mov_b32 v168, v12
    v_add_f32 v171, v168, v168
    v_cos_f32 v169, v168
    v_sin_f32 v170, v168
    v_cos_f32 v172, v171
    v_sin_f32 v173, v171
    v_cvt_pk_bf16_f32 v176, v169, v170
    v_cvt_pk_bf16_f32 v192, -v170, v169
    v_cvt_pk_bf16_f32 v48, v172, v173
    v_cvt_pk_bf16_f32 v52, -v173, v172
    v_fmamk_f32 v168, v11, 0x3f800000, v12
    v_add_f32 v171, v168, v168
    v_cos_f32 v169, v168
    v_sin_f32 v170, v168
    v_cos_f32 v172, v171
    v_sin_f32 v173, v171
    v_cvt_pk_bf16_f32 v177, v169, v170
    v_cvt_pk_bf16_f32 v193, -v170, v169
    v_cvt_pk_bf16_f32 v49, v172, v173
    v_cvt_pk_bf16_f32 v53, -v173, v172
    v_fmamk_f32 v168, v11, 0x40000000, v12
    v_add_f32 v171, v168, v168
    v_cos_f32 v169, v168
    v_sin_f32 v170, v168
    v_cos_f32 v172, v171
    v_sin_f32 v173, v171
    v_cvt_pk_bf16_f32 v178, v169, v170
    v_cvt_pk_bf16_f32 v194, -v170, v169
    v_cvt_pk_bf16_f32 v50, v172, v173
    v_cvt_pk_bf16_f32 v54, -v173, v172
    v_fmamk_f32 v168, v11, 0x40400000, v12
    v_add_f32 v171, v168, v168
    v_cos_f32 v169, v168
    v_sin_f32 v170, v168
    v_cos_f32 v172, v171
    v_sin_f32 v173, v171
    v_cvt_pk_bf16_f32 v179, v169, v170
    v_cvt_pk_bf16_f32 v195, -v170, v169
    v_cvt_pk_bf16_f32 v51, v172, v173
    v_cvt_pk_bf16_f32 v55, -v173, v172
    v_xor_b32 v180, v10, v176
    v_xor_b32 v181, v10, v177
    v_xor_b32 v182, v10, v178
    v_xor_b32 v183, v10, v179
    v_mov_b32 v184, v176
    v_xor_b32 v185, s50, v177
    v_mov_b32 v186, v178
    v_xor_b32 v187, s50, v179
    v_mov_b32 v188, v180
    v_xor_b32 v189, s50, v181
    v_mov_b32 v190, v182
    v_xor_b32 v191, s50, v183
    v_xor_b32 v196, v10, v192
    v_xor_b32 v197, v10, v193
    v_xor_b32 v198, v10, v194
    v_xor_b32 v199, v10, v195
    v_mov_b32 v200, v192
    v_xor_b32 v201, s50, v193
    v_mov_b32 v202, v194
    v_xor_b32 v203, s50, v195
    v_mov_b32 v204, v196
    v_xor_b32 v205, s50, v197
    v_mov_b32 v206, v198
    v_xor_b32 v207, s50, v199
    v_bfe_u32 v168, v1, 3, 1
    s_lshl_b32 s50, s3, 1
    v_add_u32 v168, s50, v168
    v_cvt_f32_u32 v168, v168
    v_mul_f32 v168, 0x3c000000, v168
    v_add_f32 v172, 0, v13
    v_add_f32 v173, 0x3f800000, v13
    v_add_f32 v174, 0x40000000, v13
    v_add_f32 v175, 0x40400000, v13
    v_add_f32 v169, 0, v168
    v_mul_f32 v14, v169, v172
    v_cos_f32 v56, v14
    v_sin_f32 v88, v14
    v_mul_f32 v15, v169, v173
    v_cos_f32 v57, v15
    v_sin_f32 v89, v15
    v_mul_f32 v14, v169, v174
    v_cos_f32 v58, v14
    v_sin_f32 v90, v14
    v_mul_f32 v15, v169, v175
    v_cos_f32 v59, v15
    v_sin_f32 v91, v15
    v_add_f32 v169, 0x3b000000, v168
    v_mul_f32 v14, v169, v172
    v_cos_f32 v60, v14
    v_sin_f32 v92, v14
    v_mul_f32 v15, v169, v173
    v_cos_f32 v61, v15
    v_sin_f32 v93, v15
    v_mul_f32 v14, v169, v174
    v_cos_f32 v62, v14
    v_sin_f32 v94, v14
    v_mul_f32 v15, v169, v175
    v_cos_f32 v63, v15
    v_sin_f32 v95, v15
    v_add_f32 v169, 0x3b800000, v168
    v_mul_f32 v14, v169, v172
    v_cos_f32 v64, v14
    v_sin_f32 v96, v14
    v_mul_f32 v15, v169, v173
    v_cos_f32 v65, v15
    v_sin_f32 v97, v15
    v_mul_f32 v14, v169, v174
    v_cos_f32 v66, v14
    v_sin_f32 v98, v14
    v_mul_f32 v15, v169, v175
    v_cos_f32 v67, v15
    v_sin_f32 v99, v15
    v_add_f32 v169, 0x3bc00000, v168
    v_mul_f32 v14, v169, v172
    v_cos_f32 v68, v14
    v_sin_f32 v100, v14
    v_mul_f32 v15, v169, v173
    v_cos_f32 v69, v15
    v_sin_f32 v101, v15
    v_mul_f32 v14, v169, v174
    v_cos_f32 v70, v14
    v_sin_f32 v102, v14
    v_mul_f32 v15, v169, v175
    v_cos_f32 v71, v15
    v_sin_f32 v103, v15
    v_lshlrev_b32 v168, 6, v1
    v_add_u32 v168, 20480, v168
    s_cmp_lg_u32 s3, 0
    s_cbranch_scc1 L_pdone_62
    s_mov_b32 s48, 0
L_poll_61:
    buffer_load_dword v169, v168, s[28:31], 0 offen sc1
    buffer_load_dword v170, v168, s[28:31], s98 offen sc1
    buffer_load_dword v171, v168, s[28:31], s99 offen sc1
    buffer_load_dword v172, v168, s[28:31], s100 offen sc1
    s_add_u32 s48, s48, 1
    s_waitcnt vmcnt(0)
    v_xor_b32 v169, s101, v169
    v_xor_b32 v170, s101, v170
    v_xor_b32 v171, s101, v171
    v_xor_b32 v172, s101, v172
    v_readfirstlane_b32 s47, v169
    v_writelane_b32 v169, 0, 0
    v_or_b32 v169, v169, v170
    v_or_b32 v169, v169, v171
    v_or_b32 v169, v169, v172
    v_cmp_ne_u32 vcc, 0, v169
    s_cbranch_vccz L_prest_63
    s_cmp_lt_u32 s48, 400000
    s_cbranch_scc1 L_poll_61
L_prest_63:
L_pdone_62:
    s_barrier
    buffer_load_dword v20, v4, s[32:35], s56 offen sc1
    buffer_load_dword v21, v4, s[32:35], s57 offen sc1
    buffer_load_dword v22, v4, s[32:35], s58 offen sc1
    buffer_load_dword v23, v4, s[32:35], s59 offen sc1
    buffer_load_dword v24, v4, s[32:35], s60 offen sc1
    buffer_load_dword v25, v4, s[32:35], s61 offen sc1
    buffer_load_dword v26, v4, s[32:35], s62 offen sc1
    buffer_load_dword v27, v4, s[32:35], s63 offen sc1
    buffer_load_dword v28, v4, s[32:35], s64 offen sc1
    buffer_load_dword v29, v4, s[32:35], s65 offen sc1
    buffer_load_dword v30, v4, s[32:35], s66 offen sc1
    buffer_load_dword v31, v4, s[32:35], s67 offen sc1
    buffer_load_dword v17, v4, s[32:35], s53 offen sc1
    buffer_load_dword v18, v4, s[32:35], s54 offen sc1
    buffer_load_dword v19, v4, s[32:35], s55 offen sc1
    s_cmp_lg_u32 s3, 0
    s_cbranch_scc1 L_t0d_65
    s_cmp_eq_u32 s47, 0
    s_cbranch_scc1 L_t0d_65
    v_mov_b32 v168, 20480
    s_mov_b32 s48, 0
L_t0p_64:
    buffer_load_dword v169, v168, s[28:31], 0 offen sc1
    s_add_u32 s48, s48, 1
    s_waitcnt vmcnt(0)
    v_readfirstlane_b32 s49, v169
    s_nop 3
    s_cmp_eq_u32 s49, s101
    s_cbranch_scc1 L_t0d_65
    s_cmp_lt_u32 s48, 400000
    s_cbranch_scc1 L_t0p_64
L_t0d_65:
    buffer_load_dword v16, v4, s[32:35], s52 offen sc1
    s_waitcnt vmcnt(12)
    v_mfma_f32_16x16x32_bf16 v[124:127], v[48:51], v[20:23], 0
    v_mfma_f32_16x16x32_bf16 v[140:143], v[52:55], v[20:23], 0
    s_waitcnt vmcnt(8)
    v_mfma_f32_16x16x32_bf16 v[128:131], v[48:51], v[24:27], 0
    v_mfma_f32_16x16x32_bf16 v[144:147], v[52:55], v[24:27], 0
    s_waitcnt vmcnt(4)
    v_mfma_f32_16x16x32_bf16 v[132:135], v[48:51], v[28:31], 0
    v_mfma_f32_16x16x32_bf16 v[148:151], v[52:55], v[28:31], 0
    s_waitcnt vmcnt(0)
    v_mfma_f32_16x16x32_bf16 v[120:123], v[48:51], v[16:19], 0
    v_mfma_f32_16x16x32_bf16 v[136:139], v[52:55], v[16:19], 0
    s_nop 6
    v_pk_mul_f32 v[168:169], v[120:121], v[56:57]
    v_pk_mul_f32 v[170:171], v[136:137], v[56:57]
    v_pk_fma_f32 v[168:169], v[136:137], v[88:89], v[168:169]
    v_pk_fma_f32 v[170:171], v[120:121], v[88:89], v[170:171] neg_lo:[1,0,0] neg_hi:[1,0,0]
    v_cvt_pk_bf16_f32 v152, v168, v170
    v_cvt_pk_bf16_f32 v156, v169, v171
    v_pk_mul_f32 v[172:173], v[122:123], v[58:59]
    v_pk_mul_f32 v[174:175], v[138:139], v[58:59]
    v_pk_fma_f32 v[172:173], v[138:139], v[90:91], v[172:173]
    v_pk_fma_f32 v[174:175], v[122:123], v[90:91], v[174:175] neg_lo:[1,0,0] neg_hi:[1,0,0]
    v_cvt_pk_bf16_f32 v160, v172, v174
    v_cvt_pk_bf16_f32 v164, v173, v175
    v_pk_mul_f32 v[168:169], v[124:125], v[60:61]
    v_pk_mul_f32 v[170:171], v[140:141], v[60:61]
    v_pk_fma_f32 v[168:169], v[140:141], v[92:93], v[168:169]
    v_pk_fma_f32 v[170:171], v[124:125], v[92:93], v[170:171] neg_lo:[1,0,0] neg_hi:[1,0,0]
    v_cvt_pk_bf16_f32 v153, v168, v170
    v_cvt_pk_bf16_f32 v157, v169, v171
    v_pk_mul_f32 v[172:173], v[126:127], v[62:63]
    v_pk_mul_f32 v[174:175], v[142:143], v[62:63]
    v_pk_fma_f32 v[172:173], v[142:143], v[94:95], v[172:173]
    v_pk_fma_f32 v[174:175], v[126:127], v[94:95], v[174:175] neg_lo:[1,0,0] neg_hi:[1,0,0]
    v_cvt_pk_bf16_f32 v161, v172, v174
    v_cvt_pk_bf16_f32 v165, v173, v175
    v_pk_mul_f32 v[168:169], v[128:129], v[64:65]
    v_pk_mul_f32 v[170:171], v[144:145], v[64:65]
    v_pk_fma_f32 v[168:169], v[144:145], v[96:97], v[168:169]
    v_pk_fma_f32 v[170:171], v[128:129], v[96:97], v[170:171] neg_lo:[1,0,0] neg_hi:[1,0,0]
    v_cvt_pk_bf16_f32 v154, v168, v170
    v_cvt_pk_bf16_f32 v158, v169, v171
    v_pk_mul_f32 v[172:173], v[130:131], v[66:67]
    v_pk_mul_f32 v[174:175], v[146:147], v[66:67]
    v_pk_fma_f32 v[172:173], v[146:147], v[98:99], v[172:173]
    v_pk_fma_f32 v[174:175], v[130:131], v[98:99], v[174:175] neg_lo:[1,0,0] neg_hi:[1,0,0]
    v_cvt_pk_bf16_f32 v162, v172, v174
    v_cvt_pk_bf16_f32 v166, v173, v175
    v_pk_mul_f32 v[168:169], v[132:133], v[68:69]
    v_pk_mul_f32 v[170:171], v[148:149], v[68:69]
    v_pk_fma_f32 v[168:169], v[148:149], v[100:101], v[168:169]
    v_pk_fma_f32 v[170:171], v[132:133], v[100:101], v[170:171] neg_lo:[1,0,0] neg_hi:[1,0,0]
    v_cvt_pk_bf16_f32 v155, v168, v170
    v_cvt_pk_bf16_f32 v159, v169, v171
    v_pk_mul_f32 v[172:173], v[134:135], v[70:71]
    v_pk_mul_f32 v[174:175], v[150:151], v[70:71]
    v_pk_fma_f32 v[172:173], v[150:151], v[102:103], v[172:173]
    v_pk_fma_f32 v[174:175], v[134:135], v[102:103], v[174:175] neg_lo:[1,0,0] neg_hi:[1,0,0]
    v_cvt_pk_bf16_f32 v163, v172, v174
    v_cvt_pk_bf16_f32 v167, v173, v175
    ds_write_b128 v7, v[152:155] offset:0
    ds_write_b128 v7, v[156:159] offset:1024
    ds_write_b128 v7, v[160:163] offset:2048
    ds_write_b128 v7, v[164:167] offset:3072
    s_waitcnt lgkmcnt(0)
    s_barrier
    ds_read_b128 v[16:19], v8 offset:0
    ds_read_b128 v[20:23], v9 offset:0
    ds_read_b128 v[24:27], v8 offset:2048
    ds_read_b128 v[28:31], v9 offset:2048
    s_waitcnt lgkmcnt(2)
    v_mfma_f32_16x16x32_bf16 v[120:123], v[16:19], v[176:179], 0
    v_mfma_f32_16x16x32_bf16 v[136:139], v[16:19], v[192:195], 0
    v_mfma_f32_16x16x32_bf16 v[124:127], v[16:19], v[184:187], 0
    v_mfma_f32_16x16x32_bf16 v[140:143], v[16:19], v[200:203], 0
    v_mfma_f32_16x16x32_bf16 v[120:123], v[20:23], v[180:183], v[120:123]
    v_mfma_f32_16x16x32_bf16 v[136:139], v[20:23], v[196:199], v[136:139]
    v_mfma_f32_16x16x32_bf16 v[124:127], v[20:23], v[188:191], v[124:127]
    v_mfma_f32_16x16x32_bf16 v[140:143], v[20:23], v[204:207], v[140:143]
    s_waitcnt lgkmcnt(0)
    v_mfma_f32_16x16x32_bf16 v[128:131], v[24:27], v[176:179], 0
    v_mfma_f32_16x16x32_bf16 v[144:147], v[24:27], v[192:195], 0
    v_mfma_f32_16x16x32_bf16 v[132:135], v[24:27], v[184:187], 0
    v_mfma_f32_16x16x32_bf16 v[148:151], v[24:27], v[200:203], 0
    v_mfma_f32_16x16x32_bf16 v[128:131], v[28:31], v[180:183], v[128:131]
    v_mfma_f32_16x16x32_bf16 v[144:147], v[28:31], v[196:199], v[144:147]
    v_mfma_f32_16x16x32_bf16 v[132:135], v[28:31], v[188:191], v[132:135]
    v_mfma_f32_16x16x32_bf16 v[148:151], v[28:31], v[204:207], v[148:151]
    v_cvt_pk_bf16_f32 v152, v120, -v136
    v_cvt_pk_bf16_f32 v153, v121, -v137
    v_cvt_pk_bf16_f32 v154, v122, -v138
    v_cvt_pk_bf16_f32 v155, v123, -v139
    buffer_store_dwordx4 v[152:155], v6, s[36:39], s68 offen  nt
    v_cvt_pk_bf16_f32 v156, v124, -v140
    v_cvt_pk_bf16_f32 v157, v125, -v141
    v_cvt_pk_bf16_f32 v158, v126, -v142
    v_cvt_pk_bf16_f32 v159, v127, -v143
    buffer_store_dwordx4 v[156:159], v6, s[36:39], s69 offen  nt
    v_cvt_pk_bf16_f32 v160, v128, -v144
    v_cvt_pk_bf16_f32 v161, v129, -v145
    v_cvt_pk_bf16_f32 v162, v130, -v146
    v_cvt_pk_bf16_f32 v163, v131, -v147
    buffer_store_dwordx4 v[160:163], v6, s[36:39], s70 offen  nt
    v_cvt_pk_bf16_f32 v164, v132, -v148
    v_cvt_pk_bf16_f32 v165, v133, -v149
    v_cvt_pk_bf16_f32 v166, v134, -v150
    v_cvt_pk_bf16_f32 v167, v135, -v151
    buffer_store_dwordx4 v[164:167], v6, s[36:39], s71 offen  nt
    s_cmp_lg_u32 s75, 0
    s_cbranch_scc1 L_fin
    v_lshlrev_b32 v2, 6, v1
    v_add_u32 v2, 69632, v2
    s_lshl_b32 s49, s101, 4
    s_mov_b32 s48, 0
L_bchk_66:
    s_mov_b32 s50, 0
    buffer_load_dword v4, v2, s[28:31], s50 offen sc1
    s_mov_b32 s50, 4096
    buffer_load_dword v5, v2, s[28:31], s50 offen sc1
    s_mov_b32 s50, 8192
    buffer_load_dword v6, v2, s[28:31], s50 offen sc1
    s_mov_b32 s50, 12288
    buffer_load_dword v7, v2, s[28:31], s50 offen sc1
    s_add_u32 s48, s48, 1
    s_waitcnt vmcnt(0)
    v_xor_b32 v4, s49, v4
    v_xor_b32 v5, s49, v5
    v_xor_b32 v6, s49, v6
    v_xor_b32 v7, s49, v7
    v_or_b32 v4, v4, v5
    v_or_b32 v4, v4, v6
    v_or_b32 v4, v4, v7
    v_lshrrev_b32 v4, 4, v4
    v_cmp_ne_u32 vcc, 0, v4
    s_cbranch_vccz L_bchkd_67
    s_cmp_lt_u32 s48, 400000
    s_cbranch_scc1 L_bchk_66
L_bchkd_67:
    s_mov_b32 s48, 0
    v_mov_b32 v2, s48
    v_mov_b32 v3, s101
    s_mov_b64 exec, 1
    buffer_store_dword v3, v2, s[28:31], 0 offen sc1
    s_mov_b64 exec, -1
    s_branch L_fin
L_special_53:
    s_cmp_lg_u32 s45, 0
    s_cbranch_scc1 L_sp1_68
    v_lshl_add_u32 v236, v3, 7, v2
    v_sub_u32 v237, 159, v236
    s_mov_b32 s48, 49152
    v_lshl_add_u32 v238, v236, 1, s48
    s_mov_b32 s49, 51200
    v_lshl_add_u32 v239, v237, 1, s49
    ds_read_u16_d16_hi v204, v238 offset:0
    ds_read_u16_d16_hi v205, v238 offset:64
    ds_read_u16_d16_hi v206, v238 offset:128
    ds_read_u16_d16_hi v207, v238 offset:192
    ds_read_u16_d16_hi v208, v238 offset:512
    ds_read_u16_d16_hi v209, v238 offset:576
    ds_read_u16_d16_hi v210, v238 offset:640
    ds_read_u16_d16_hi v211, v238 offset:704
    ds_read_u16_d16_hi v212, v239 offset:704
    ds_read_u16_d16_hi v213, v239 offset:640
    ds_read_u16_d16_hi v214, v239 offset:576
    ds_read_u16_d16_hi v215, v239 offset:512
    ds_read_u16_d16_hi v216, v239 offset:192
    ds_read_u16_d16_hi v217, v239 offset:128
    ds_read_u16_d16_hi v218, v239 offset:64
    ds_read_u16_d16_hi v219, v239 offset:0
    ds_read_u16_d16_hi v220, v238 offset:1024
    ds_read_u16_d16_hi v221, v238 offset:1088
    ds_read_u16_d16_hi v222, v238 offset:1152
    ds_read_u16_d16_hi v223, v238 offset:1216
    ds_read_u16_d16_hi v224, v238 offset:1536
    ds_read_u16_d16_hi v225, v238 offset:1600
    ds_read_u16_d16_hi v226, v238 offset:1664
    ds_read_u16_d16_hi v227, v238 offset:1728
    ds_read_u16_d16_hi v228, v239 offset:1728
    ds_read_u16_d16_hi v229, v239 offset:1664
    ds_read_u16_d16_hi v230, v239 offset:1600
    ds_read_u16_d16_hi v231, v239 offset:1536
    ds_read_u16_d16_hi v232, v239 offset:1216
    ds_read_u16_d16_hi v233, v239 offset:1152
    ds_read_u16_d16_hi v234, v239 offset:1088
    ds_read_u16_d16_hi v235, v239 offset:1024
    v_pk_mul_f32 v[188:189], v[112:113], v[80:81]
    v_pk_mul_f32 v[190:191], v[128:129], v[80:81]
    v_pk_fma_f32 v[80:81], v[128:129], v[96:97], v[188:189] neg_lo:[1,0,0] neg_hi:[1,0,0]
    v_pk_fma_f32 v[96:97], v[112:113], v[96:97], v[190:191]
    v_pk_mul_f32 v[192:193], v[114:115], v[82:83]
    v_pk_mul_f32 v[194:195], v[130:131], v[82:83]
    v_pk_fma_f32 v[82:83], v[130:131], v[98:99], v[192:193] neg_lo:[1,0,0] neg_hi:[1,0,0]
    v_pk_fma_f32 v[98:99], v[114:115], v[98:99], v[194:195]
    v_pk_mul_f32 v[188:189], v[116:117], v[84:85]
    v_pk_mul_f32 v[190:191], v[132:133], v[84:85]
    v_pk_fma_f32 v[84:85], v[132:133], v[100:101], v[188:189] neg_lo:[1,0,0] neg_hi:[1,0,0]
    v_pk_fma_f32 v[100:101], v[116:117], v[100:101], v[190:191]
    v_pk_mul_f32 v[192:193], v[118:119], v[86:87]
    v_pk_mul_f32 v[194:195], v[134:135], v[86:87]
    v_pk_fma_f32 v[86:87], v[134:135], v[102:103], v[192:193] neg_lo:[1,0,0] neg_hi:[1,0,0]
    v_pk_fma_f32 v[102:103], v[118:119], v[102:103], v[194:195]
    v_pk_mul_f32 v[188:189], v[120:121], v[88:89]
    v_pk_mul_f32 v[190:191], v[136:137], v[88:89]
    v_pk_fma_f32 v[88:89], v[136:137], v[104:105], v[188:189]
    v_pk_fma_f32 v[104:105], v[120:121], v[104:105], v[190:191] neg_lo:[1,0,0] neg_hi:[1,0,0]
    v_pk_mul_f32 v[192:193], v[122:123], v[90:91]
    v_pk_mul_f32 v[194:195], v[138:139], v[90:91]
    v_pk_fma_f32 v[90:91], v[138:139], v[106:107], v[192:193]
    v_pk_fma_f32 v[106:107], v[122:123], v[106:107], v[194:195] neg_lo:[1,0,0] neg_hi:[1,0,0]
    v_pk_mul_f32 v[188:189], v[124:125], v[92:93]
    v_pk_mul_f32 v[190:191], v[140:141], v[92:93]
    v_pk_fma_f32 v[92:93], v[140:141], v[108:109], v[188:189]
    v_pk_fma_f32 v[108:109], v[124:125], v[108:109], v[190:191] neg_lo:[1,0,0] neg_hi:[1,0,0]
    v_pk_mul_f32 v[192:193], v[126:127], v[94:95]
    v_pk_mul_f32 v[194:195], v[142:143], v[94:95]
    v_pk_fma_f32 v[94:95], v[142:143], v[110:111], v[192:193]
    v_pk_fma_f32 v[110:111], v[126:127], v[110:111], v[194:195] neg_lo:[1,0,0] neg_hi:[1,0,0]
    v_mov_b32 v144, v172
    v_mov_b32 v145, v173
    v_mov_b32 v146, v174
    v_mov_b32 v147, v175
    v_mov_b32 v148, v176
    v_mov_b32 v149, v177
    v_mov_b32 v150, v178
    v_mov_b32 v151, v179
    v_mov_b32 v152, v180
    v_mov_b32 v153, v181
    v_mov_b32 v154, v182
    v_mov_b32 v155, v183
    v_mov_b32 v156, v184
    v_mov_b32 v157, v185
    v_mov_b32 v158, v186
    v_mov_b32 v159, v187
    s_mov_b32 s45, 1
    s_branch L_fwd_55
L_sp1_68:
    v_cmp_eq_u32 vcc, 0, v1
    v_add_f32 v188, v204, v252
    v_mul_f32 v188, 0.5, v188
    v_sub_f32 v189, v220, v253
    v_mul_f32 v189, 0.5, v189
    v_cndmask_b32 v204, v204, v188, vcc
    v_cndmask_b32 v220, v220, v189, vcc
    v_add_f32 v188, v212, v254
    v_mul_f32 v188, 0.5, v188
    v_sub_f32 v189, v228, v255
    v_mul_f32 v189, 0.5, v189
    v_cndmask_b32 v212, v212, v188, vcc
    v_cndmask_b32 v228, v228, v189, vcc
    v_pk_mul_f32 v[188:189], v[112:113], v[204:205]
    v_pk_mul_f32 v[190:191], v[128:129], v[204:205]
    v_pk_fma_f32 v[188:189], v[128:129], v[220:221], v[188:189] neg_lo:[1,0,0] neg_hi:[1,0,0]
    v_pk_fma_f32 v[190:191], v[112:113], v[220:221], v[190:191]
    v_pk_add_f32 v[190:191], v[80:81], v[190:191] neg_lo:[0,1] neg_hi:[0,1]
    v_pk_add_f32 v[188:189], v[96:97], v[188:189]
    v_cvt_pk_bf16_f32 v144, v190, -v188
    v_cvt_pk_bf16_f32 v145, v191, -v189
    v_pk_mul_f32 v[192:193], v[114:115], v[206:207]
    v_pk_mul_f32 v[194:195], v[130:131], v[206:207]
    v_pk_fma_f32 v[192:193], v[130:131], v[222:223], v[192:193] neg_lo:[1,0,0] neg_hi:[1,0,0]
    v_pk_fma_f32 v[194:195], v[114:115], v[222:223], v[194:195]
    v_pk_add_f32 v[194:195], v[82:83], v[194:195] neg_lo:[0,1] neg_hi:[0,1]
    v_pk_add_f32 v[192:193], v[98:99], v[192:193]
    v_cvt_pk_bf16_f32 v146, v194, -v192
    v_cvt_pk_bf16_f32 v147, v195, -v193
    v_pk_mul_f32 v[188:189], v[116:117], v[208:209]
    v_pk_mul_f32 v[190:191], v[132:133], v[208:209]
    v_pk_fma_f32 v[188:189], v[132:133], v[224:225], v[188:189] neg_lo:[1,0,0] neg_hi:[1,0,0]
    v_pk_fma_f32 v[190:191], v[116:117], v[224:225], v[190:191]
    v_pk_add_f32 v[190:191], v[84:85], v[190:191] neg_lo:[0,1] neg_hi:[0,1]
    v_pk_add_f32 v[188:189], v[100:101], v[188:189]
    v_cvt_pk_bf16_f32 v148, v190, -v188
    v_cvt_pk_bf16_f32 v149, v191, -v189
    v_pk_mul_f32 v[192:193], v[118:119], v[210:211]
    v_pk_mul_f32 v[194:195], v[134:135], v[210:211]
    v_pk_fma_f32 v[192:193], v[134:135], v[226:227], v[192:193] neg_lo:[1,0,0] neg_hi:[1,0,0]
    v_pk_fma_f32 v[194:195], v[118:119], v[226:227], v[194:195]
    v_pk_add_f32 v[194:195], v[86:87], v[194:195] neg_lo:[0,1] neg_hi:[0,1]
    v_pk_add_f32 v[192:193], v[102:103], v[192:193]
    v_cvt_pk_bf16_f32 v150, v194, -v192
    v_cvt_pk_bf16_f32 v151, v195, -v193
    v_pk_mul_f32 v[188:189], v[120:121], v[212:213]
    v_pk_mul_f32 v[190:191], v[136:137], v[212:213]
    v_pk_fma_f32 v[188:189], v[136:137], v[228:229], v[188:189]
    v_pk_fma_f32 v[190:191], v[120:121], v[228:229], v[190:191] neg_lo:[1,0,0] neg_hi:[1,0,0]
    v_pk_add_f32 v[190:191], v[88:89], v[190:191] neg_lo:[0,1] neg_hi:[0,1]
    v_pk_add_f32 v[188:189], v[104:105], v[188:189]
    v_cvt_pk_bf16_f32 v152, v190, -v188
    v_cvt_pk_bf16_f32 v153, v191, -v189
    v_pk_mul_f32 v[192:193], v[122:123], v[214:215]
    v_pk_mul_f32 v[194:195], v[138:139], v[214:215]
    v_pk_fma_f32 v[192:193], v[138:139], v[230:231], v[192:193]
    v_pk_fma_f32 v[194:195], v[122:123], v[230:231], v[194:195] neg_lo:[1,0,0] neg_hi:[1,0,0]
    v_pk_add_f32 v[194:195], v[90:91], v[194:195] neg_lo:[0,1] neg_hi:[0,1]
    v_pk_add_f32 v[192:193], v[106:107], v[192:193]
    v_cvt_pk_bf16_f32 v154, v194, -v192
    v_cvt_pk_bf16_f32 v155, v195, -v193
    v_pk_mul_f32 v[188:189], v[124:125], v[216:217]
    v_pk_mul_f32 v[190:191], v[140:141], v[216:217]
    v_pk_fma_f32 v[188:189], v[140:141], v[232:233], v[188:189]
    v_pk_fma_f32 v[190:191], v[124:125], v[232:233], v[190:191] neg_lo:[1,0,0] neg_hi:[1,0,0]
    v_pk_add_f32 v[190:191], v[92:93], v[190:191] neg_lo:[0,1] neg_hi:[0,1]
    v_pk_add_f32 v[188:189], v[108:109], v[188:189]
    v_cvt_pk_bf16_f32 v156, v190, -v188
    v_cvt_pk_bf16_f32 v157, v191, -v189
    v_pk_mul_f32 v[192:193], v[126:127], v[218:219]
    v_pk_mul_f32 v[194:195], v[142:143], v[218:219]
    v_pk_fma_f32 v[192:193], v[142:143], v[234:235], v[192:193]
    v_pk_fma_f32 v[194:195], v[126:127], v[234:235], v[194:195] neg_lo:[1,0,0] neg_hi:[1,0,0]
    v_pk_add_f32 v[194:195], v[94:95], v[194:195] neg_lo:[0,1] neg_hi:[0,1]
    v_pk_add_f32 v[192:193], v[110:111], v[192:193]
    v_cvt_pk_bf16_f32 v158, v194, -v192
    v_cvt_pk_bf16_f32 v159, v195, -v193
    s_branch L_inv_54
L_fin:
L_exit:
    s_endpgm
.section .rodata,"a"
.p2align 6
.amdhsa_kernel concat_heads__spectral_gfnet__ssm_conv_h3__prompt_kernel
  .amdhsa_next_free_vgpr 256
  .amdhsa_next_free_sgpr 102
  .amdhsa_accum_offset 256
  .amdhsa_group_segment_fixed_size 0
  .amdhsa_kernarg_size 96
  .amdhsa_user_sgpr_count 2
  .amdhsa_user_sgpr_kernarg_segment_ptr 1
  .amdhsa_system_sgpr_workgroup_id_x 1
.end_amdhsa_kernel
```
